```python
import torch

def _softmax(x, axis=-1):
    return torch.softmax(x, dim=axis)
def _gelu(x):
    return torch.nn.functional.gelu(x, approximate="tanh")
def _silu(x):
    return torch.nn.functional.silu(x)
def _sigmoid(x):
    return torch.sigmoid(x)
def _layernorm(x, axis=-1, eps=1e-5):
    m = x.mean(dim=axis, keepdim=True)
    v = x.var(dim=axis, keepdim=True, unbiased=False)
    return (x - m) / torch.sqrt(v + eps)
def _scatter_add(tgt, idx, src, axis=0):
    return tgt.clone().index_add_(axis, idx, src)
def _segment_sum(src, seg, n):
    out = torch.zeros((n,) + src.shape[1:], dtype=src.dtype)
    return out.index_add_(0, seg, src)
def _pad(x, pw):
    flat = tuple(v for pair in reversed(pw) for v in pair)
    return torch.nn.functional.pad(x, flat)

kernel_name = 'sequential_preLN__softmax_full_mha__dense_activation_mish__prompt'

def setup_inputs():

    _w = (lambda a: (lambda t: t.to(torch.bfloat16) if t.is_floating_point() else t)(torch.as_tensor(a)))
    def _A_setup():
        B, S, D = 1, 2048, 512
        return {
            "x": _w((lambda *s: torch.randn(*s, dtype=torch.bfloat16) * 0.05)(B, S, D)),
            "wqkv": _w((lambda *s: torch.randn(*s, dtype=torch.bfloat16) * 0.05)(D, 3 * D)),
            "wo": _w((lambda *s: torch.randn(*s, dtype=torch.bfloat16) * 0.05)(D, D)),
        }
    _A_in = _A_setup()

    def _B_setup():
        B, S, D, F = 1, 2048, 512, 1792
        return {
            "x": _w((lambda *s: torch.randn(*s, dtype=torch.bfloat16) * 0.05)(B, S, D)),
            "w1": _w((lambda *s: torch.randn(*s, dtype=torch.bfloat16) * 0.8)(D, F) * (D ** -0.5)),
            "b1": _w((lambda *s: torch.randn(*s, dtype=torch.bfloat16) * 0.4)(F)),
            "w2": _w((lambda *s: torch.randn(*s, dtype=torch.bfloat16) * 0.2)(F, D) * (F ** -0.5)),
        }
    _B_in = _B_setup()

    return {
        "A_x": _A_in["x"],
        "A_wqkv": _A_in["wqkv"],
        "A_wo": _A_in["wo"],
        "B_x": _B_in["x"],
        "B_w1": _B_in["w1"],
        "B_b1": _B_in["b1"],
        "B_w2": _B_in["w2"],
    }

def reference(A_x, A_wqkv, A_wo, B_x, B_w1, B_b1, B_w2):
    def _A_ref(x, wqkv, wo):
        B, S, D = x.shape
        H = 32; Dh = D // H
        qkv = (lambda x, *d: x.permute(*d))((x @ wqkv).reshape(B, S, 3, H, Dh), 2, 0, 3, 1, 4)
        q, k, v = qkv[0], qkv[1], qkv[2]
        scale = Dh ** -0.5
        scores = torch.einsum("bhqd,bhkd->bhqk", q, k) * scale
        p = _softmax(scores, axis=-1)
        o = torch.einsum("bhqk,bhkd->bhqd", p, v)
        return (lambda x, *d: x.permute(*d))(o, 0, 2, 1, 3).reshape(B, S, D) @ wo

    def _B_ref(x, w1, b1, w2):
        h = torch.einsum("bsd,df->bsf", x, w1) + b1
        sp = torch.log1p(torch.exp(-torch.abs(h))) + torch.where(h > 0, h, torch.zeros_like(h))
        act = h * torch.tanh(sp)
        return torch.einsum("bsf,fd->bsd", act, w2)

    x = A_x
    h = x + _A_ref(_layernorm(x, axis=-1), A_wqkv, A_wo)
    h2 = h + _B_ref(_layernorm(h, axis=-1), B_w1, B_b1, B_w2)
    return h2
```

```asm
; @launch grid=(256,1,1) block=(768,1,1) lds=163840
.amdgcn_target "amdgcn-amd-amdhsa--gfx950"
.text
.globl sequential_preLN__softmax_full_mha__dense_activation_mish__prompt_kernel
.p2align 8
.type sequential_preLN__softmax_full_mha__dense_activation_mish__prompt_kernel,@function
sequential_preLN__softmax_full_mha__dense_activation_mish__prompt_kernel:
    s_cmp_ge_u32 s2, 256
    s_cbranch_scc1 Lexit
    s_load_dwordx16 s[64:79], s[0:1], 0
    s_load_dwordx4 s[80:83], s[0:1], 64
    s_getpc_b64 s[40:41]
    v_lshlrev_b32 v5, 7, v0
    v_cmp_gt_u32 vcc, Lexit - sequential_preLN__softmax_full_mha__dense_activation_mish__prompt_kernel - 4 - 128, v5
    s_and_saveexec_b64 s[42:43], vcc
    s_cbranch_execz Lnopf
    global_load_dword v6, v5, s[40:41]
    Lnopf:
    s_mov_b64 exec, -1
    v_lshrrev_b32 v1, 6, v0
    v_and_b32 v0, 63, v0
    s_and_b32 s20, s2, 7
    v_readfirstlane_b32 s3, v1
    s_lshr_b32 s21, s2, 3
    v_lshrrev_b32 v1, 5, v0
    v_lshlrev_b32 v2, 4, v0
    v_and_b32 v3, 31, v0
    s_and_b32 s28, s20, 3
    s_lshr_b32 s29, s20, 2
    s_lshl_b32 s56, s28, 3
    s_and_b32 s30, s21, 7
    s_add_u32 s56, s56, s30
    s_lshl_b32 s57, s29, 2
    s_lshr_b32 s30, s21, 3
    s_add_u32 s57, s57, s30
    s_lshl_b32 s24, s20, 2
    s_and_b32 s30, s21, 3
    s_add_u32 s24, s24, s30
    s_lshr_b32 s25, s21, 2
    s_mov_b32 s22, s24
    s_mov_b32 s23, s25
    s_lshl_b32 s26, s28, 2
    s_add_u32 s26, s26, s30
    s_mul_i32 s27, s29, 7
    s_add_u32 s27, s27, s25
    s_cmp_lt_u32 s3, 4
    s_cbranch_scc1 Lloader
    s_sub_u32 s28, s3, 4
    s_lshl_b32 s29, s56, 6
    s_lshl_b32 s30, s28, 3
    s_add_u32 s29, s29, s30
    v_lshrrev_b32 v6, 3, v0
    v_add_u32 v7, s29, v6
    v_lshlrev_b32 v7, 10, v7
    v_and_b32 v8, 7, v0
    v_lshl_add_u32 v7, v8, 4, v7
    s_add_u32 s33, s56, s57
    s_lshl_b32 s33, s33, 7
    s_and_b32 s33, s33, 1023
    s_waitcnt lgkmcnt(0)
    s_mov_b32 s16, s64
    s_mov_b32 s17, s65
    s_mov_b32 s18, 2097152
    s_mov_b32 s19, 0x00020000
    buffer_load_dwordx4 v[64:67], v7, s[16:19], s33 offen
    s_add_u32 s33, s33, 128
    s_and_b32 s33, s33, 1023
    buffer_load_dwordx4 v[68:71], v7, s[16:19], s33 offen
    s_add_u32 s33, s33, 128
    s_and_b32 s33, s33, 1023
    buffer_load_dwordx4 v[72:75], v7, s[16:19], s33 offen
    s_add_u32 s33, s33, 128
    s_and_b32 s33, s33, 1023
    buffer_load_dwordx4 v[76:79], v7, s[16:19], s33 offen
    s_add_u32 s33, s33, 128
    s_and_b32 s33, s33, 1023
    buffer_load_dwordx4 v[80:83], v7, s[16:19], s33 offen
    s_add_u32 s33, s33, 128
    s_and_b32 s33, s33, 1023
    buffer_load_dwordx4 v[84:87], v7, s[16:19], s33 offen
    s_add_u32 s33, s33, 128
    s_and_b32 s33, s33, 1023
    buffer_load_dwordx4 v[88:91], v7, s[16:19], s33 offen
    s_add_u32 s33, s33, 128
    s_and_b32 s33, s33, 1023
    buffer_load_dwordx4 v[92:95], v7, s[16:19], s33 offen
    s_barrier
    s_mov_b32 s12, s82
    s_mov_b32 s13, s83
    s_mov_b32 s14, 20971520
    s_mov_b32 s15, 0x00020000
    s_lshr_b32 s29, s28, 2
    s_lshl_b32 s29, s29, 15
    s_and_b32 s30, s28, 3
    s_lshl_b32 s30, s30, 7
    s_add_u32 s29, s29, s30
    v_xor_b32 v9, v6, v8
    v_lshlrev_b32 v9, 4, v9
    v_lshl_add_u32 v9, v8, 9, v9
    v_add_u32 v9, s29, v9
    s_lshl_b32 s30, s28, 5
    s_add_u32 s30, s30, 163584
    v_lshlrev_b32 v10, 2, v6
    v_add_u32 v10, s30, v10
    v_mov_b32 v128, 0x3f803f80
    v_mov_b32 v129, 0x00003f80
    v_mov_b32 v130, 0x3f800000
    s_and_b32 s29, s28, 1
    s_bfe_u32 s30, s28, 0x10001
    s_lshl_b32 s31, s30, 6
    v_mul_u32_u24 v11, 3072, v1
    v_bfe_u32 v13, v0, 2, 2
    v_lshl_add_u32 v11, v13, 7, v11
    v_bfe_u32 v13, v0, 4, 1
    v_lshlrev_b32 v13, 5, v13
    v_and_b32 v14, 3, v0
    v_lshl_add_u32 v13, v14, 3, v13
    v_add_u32 v13, s31, v13
    v_bfe_u32 v14, v0, 3, 1
    v_lshlrev_b32 v14, 6, v14
    v_xor_b32 v13, v13, v14
    v_add_u32 v11, v11, v13
    v_add_u32 v11, 65536, v11
    s_lshl_b32 s32, s29, 15
    v_xor_b32 v13, v3, v1
    v_lshlrev_b32 v13, 4, v13
    v_lshlrev_b32 v14, 9, v1
    v_add_u32 v14, s32, v14
    v_xor_b32 v4, 0, v13
    v_add_u32 v4, v4, v14
    v_xor_b32 v5, 32, v13
    v_add_u32 v5, v5, v14
    v_xor_b32 v6, 64, v13
    v_add_u32 v6, v6, v14
    v_xor_b32 v7, 96, v13
    v_add_u32 v7, v7, v14
    v_mov_b32 v12, v11
    s_mov_b32 s35, 0
    s_lshl_b32 s36, s29, 7
    s_add_u32 s36, s36, 163584
    v_lshlrev_b32 v13, 2, v3
    v_add_u32 v13, s36, v13
    v_lshlrev_b32 v14, 4, v1
    v_add_u32 v14, s36, v14
    s_lshl_b32 s32, s57, 2
    s_lshl_b32 s33, s30, 1
    s_add_u32 s32, s32, s33
    s_lshl_b32 s33, s56, 1
    s_add_u32 s33, s33, s29
    s_lshl_b32 s39, s32, 16
    s_lshl_b32 s36, s33, 10
    s_add_u32 s39, s39, s36
    s_add_u32 s39, s39, 0
    s_add_u32 s36, s39, 65536
    s_lshl_b32 s37, s32, 17
    s_lshl_b32 s38, s33, 11
    s_add_u32 s37, s37, s38
    s_add_u32 s37, s37, 2097152
    s_add_u32 s38, s37, 131072
    v_and_b32 v15, 15, v0
    v_lshlrev_b32 v15, 4, v15
    v_lshl_add_u32 v15, v1, 8, v15
    v_bfe_u32 v134, v0, 4, 1
    v_lshl_add_u32 v15, v134, 17, v15
    v_mov_b32 v16, 0
    v_mov_b32 v17, 0
    v_mov_b32 v18, 0
    v_mov_b32 v19, 0
    v_mov_b32 v20, 0
    v_mov_b32 v21, 0
    v_mov_b32 v22, 0
    v_mov_b32 v23, 0
    v_mov_b32 v24, 0
    v_mov_b32 v25, 0
    v_mov_b32 v26, 0
    v_mov_b32 v27, 0
    v_mov_b32 v28, 0
    v_mov_b32 v29, 0
    v_mov_b32 v30, 0
    v_mov_b32 v31, 0
    v_mov_b32 v32, 0
    v_mov_b32 v33, 0
    v_mov_b32 v34, 0
    v_mov_b32 v35, 0
    v_mov_b32 v36, 0
    v_mov_b32 v37, 0
    v_mov_b32 v38, 0
    v_mov_b32 v39, 0
    v_mov_b32 v40, 0
    v_mov_b32 v41, 0
    v_mov_b32 v42, 0
    v_mov_b32 v43, 0
    v_mov_b32 v44, 0
    v_mov_b32 v45, 0
    v_mov_b32 v46, 0
    v_mov_b32 v47, 0
    v_mov_b32 v48, 0
    v_mov_b32 v49, 0
    v_mov_b32 v50, 0
    v_mov_b32 v51, 0
    v_mov_b32 v52, 0
    v_mov_b32 v53, 0
    v_mov_b32 v54, 0
    v_mov_b32 v55, 0
    v_mov_b32 v56, 0
    v_mov_b32 v57, 0
    v_mov_b32 v58, 0
    v_mov_b32 v59, 0
    v_mov_b32 v60, 0
    v_mov_b32 v61, 0
    v_mov_b32 v62, 0
    v_mov_b32 v63, 0
    v_mov_b32 v132, 0
    v_mov_b32 v133, 0
    v_mov_b32 v134, 0
    v_mov_b32 v135, 0
    s_waitcnt vmcnt(7)
    v_dot2_f32_bf16 v132, v64, v128, v132
    v_dot2_f32_bf16 v134, v64, v64, v134
    v_dot2_f32_bf16 v133, v65, v128, v133
    v_dot2_f32_bf16 v135, v65, v65, v135
    v_dot2_f32_bf16 v132, v66, v128, v132
    v_dot2_f32_bf16 v134, v66, v66, v134
    v_dot2_f32_bf16 v133, v67, v128, v133
    v_dot2_f32_bf16 v135, v67, v67, v135
    s_waitcnt vmcnt(6)
    v_dot2_f32_bf16 v132, v68, v128, v132
    v_dot2_f32_bf16 v134, v68, v68, v134
    v_dot2_f32_bf16 v133, v69, v128, v133
    v_dot2_f32_bf16 v135, v69, v69, v135
    v_dot2_f32_bf16 v132, v70, v128, v132
    v_dot2_f32_bf16 v134, v70, v70, v134
    v_dot2_f32_bf16 v133, v71, v128, v133
    v_dot2_f32_bf16 v135, v71, v71, v135
    s_waitcnt vmcnt(5)
    v_dot2_f32_bf16 v132, v72, v128, v132
    v_dot2_f32_bf16 v134, v72, v72, v134
    v_dot2_f32_bf16 v133, v73, v128, v133
    v_dot2_f32_bf16 v135, v73, v73, v135
    v_dot2_f32_bf16 v132, v74, v128, v132
    v_dot2_f32_bf16 v134, v74, v74, v134
    v_dot2_f32_bf16 v133, v75, v128, v133
    v_dot2_f32_bf16 v135, v75, v75, v135
    s_waitcnt vmcnt(4)
    v_dot2_f32_bf16 v132, v76, v128, v132
    v_dot2_f32_bf16 v134, v76, v76, v134
    v_dot2_f32_bf16 v133, v77, v128, v133
    v_dot2_f32_bf16 v135, v77, v77, v135
    v_dot2_f32_bf16 v132, v78, v128, v132
    v_dot2_f32_bf16 v134, v78, v78, v134
    v_dot2_f32_bf16 v133, v79, v128, v133
    v_dot2_f32_bf16 v135, v79, v79, v135
    s_waitcnt vmcnt(3)
    v_dot2_f32_bf16 v132, v80, v128, v132
    v_dot2_f32_bf16 v134, v80, v80, v134
    v_dot2_f32_bf16 v133, v81, v128, v133
    v_dot2_f32_bf16 v135, v81, v81, v135
    v_dot2_f32_bf16 v132, v82, v128, v132
    v_dot2_f32_bf16 v134, v82, v82, v134
    v_dot2_f32_bf16 v133, v83, v128, v133
    v_dot2_f32_bf16 v135, v83, v83, v135
    s_waitcnt vmcnt(2)
    v_dot2_f32_bf16 v132, v84, v128, v132
    v_dot2_f32_bf16 v134, v84, v84, v134
    v_dot2_f32_bf16 v133, v85, v128, v133
    v_dot2_f32_bf16 v135, v85, v85, v135
    v_dot2_f32_bf16 v132, v86, v128, v132
    v_dot2_f32_bf16 v134, v86, v86, v134
    v_dot2_f32_bf16 v133, v87, v128, v133
    v_dot2_f32_bf16 v135, v87, v87, v135
    s_waitcnt vmcnt(1)
    v_dot2_f32_bf16 v132, v88, v128, v132
    v_dot2_f32_bf16 v134, v88, v88, v134
    v_dot2_f32_bf16 v133, v89, v128, v133
    v_dot2_f32_bf16 v135, v89, v89, v135
    v_dot2_f32_bf16 v132, v90, v128, v132
    v_dot2_f32_bf16 v134, v90, v90, v134
    v_dot2_f32_bf16 v133, v91, v128, v133
    v_dot2_f32_bf16 v135, v91, v91, v135
    s_waitcnt vmcnt(0)
    v_dot2_f32_bf16 v132, v92, v128, v132
    v_dot2_f32_bf16 v134, v92, v92, v134
    v_dot2_f32_bf16 v133, v93, v128, v133
    v_dot2_f32_bf16 v135, v93, v93, v135
    v_dot2_f32_bf16 v132, v94, v128, v132
    v_dot2_f32_bf16 v134, v94, v94, v134
    v_dot2_f32_bf16 v133, v95, v128, v133
    v_dot2_f32_bf16 v135, v95, v95, v135
    s_nop 1
    v_add_f32 v132, v132, v133
    v_add_f32 v134, v134, v135
    s_nop 0
    v_add_f32_dpp v132, v132, v132 quad_perm:[1,0,3,2] row_mask:0xf bank_mask:0xf
    v_add_f32_dpp v134, v134, v134 quad_perm:[1,0,3,2] row_mask:0xf bank_mask:0xf
    s_nop 0
    v_add_f32_dpp v132, v132, v132 quad_perm:[2,3,0,1] row_mask:0xf bank_mask:0xf
    v_add_f32_dpp v134, v134, v134 quad_perm:[2,3,0,1] row_mask:0xf bank_mask:0xf
    s_nop 0
    v_add_f32_dpp v132, v132, v132 row_half_mirror row_mask:0xf bank_mask:0xf
    v_add_f32_dpp v134, v134, v134 row_half_mirror row_mask:0xf bank_mask:0xf
    v_mul_f32 v132, 0xbb000000, v132
    v_mul_f32 v134, 0x3b000000, v134
    v_dot2_f32_bf16 v136, v64, v129, v132
    v_dot2_f32_bf16 v137, v64, v130, v132
    v_dot2_f32_bf16 v138, v65, v129, v132
    v_dot2_f32_bf16 v139, v65, v130, v132
    v_dot2_f32_bf16 v140, v66, v129, v132
    v_dot2_f32_bf16 v141, v66, v130, v132
    v_dot2_f32_bf16 v142, v67, v129, v132
    v_dot2_f32_bf16 v143, v67, v130, v132
    v_dot2_f32_bf16 v144, v68, v129, v132
    v_dot2_f32_bf16 v145, v68, v130, v132
    v_dot2_f32_bf16 v146, v69, v129, v132
    v_dot2_f32_bf16 v147, v69, v130, v132
    v_dot2_f32_bf16 v148, v70, v129, v132
    v_dot2_f32_bf16 v149, v70, v130, v132
    v_dot2_f32_bf16 v150, v71, v129, v132
    v_dot2_f32_bf16 v151, v71, v130, v132
    v_cvt_pk_bf16_f32 v64, v136, v137
    v_cvt_pk_bf16_f32 v65, v138, v139
    v_cvt_pk_bf16_f32 v66, v140, v141
    v_cvt_pk_bf16_f32 v67, v142, v143
    ds_write_b128 v9, v[64:67] offset:0
    v_dot2_f32_bf16 v136, v72, v129, v132
    v_dot2_f32_bf16 v137, v72, v130, v132
    v_dot2_f32_bf16 v138, v73, v129, v132
    v_dot2_f32_bf16 v139, v73, v130, v132
    v_dot2_f32_bf16 v140, v74, v129, v132
    v_dot2_f32_bf16 v141, v74, v130, v132
    v_dot2_f32_bf16 v142, v75, v129, v132
    v_dot2_f32_bf16 v143, v75, v130, v132
    v_cvt_pk_bf16_f32 v68, v144, v145
    v_cvt_pk_bf16_f32 v69, v146, v147
    v_cvt_pk_bf16_f32 v70, v148, v149
    v_cvt_pk_bf16_f32 v71, v150, v151
    ds_write_b128 v9, v[68:71] offset:4096
    v_dot2_f32_bf16 v144, v76, v129, v132
    v_dot2_f32_bf16 v145, v76, v130, v132
    v_dot2_f32_bf16 v146, v77, v129, v132
    v_dot2_f32_bf16 v147, v77, v130, v132
    v_dot2_f32_bf16 v148, v78, v129, v132
    v_dot2_f32_bf16 v149, v78, v130, v132
    v_dot2_f32_bf16 v150, v79, v129, v132
    v_dot2_f32_bf16 v151, v79, v130, v132
    v_cvt_pk_bf16_f32 v72, v136, v137
    v_cvt_pk_bf16_f32 v73, v138, v139
    v_cvt_pk_bf16_f32 v74, v140, v141
    v_cvt_pk_bf16_f32 v75, v142, v143
    ds_write_b128 v9, v[72:75] offset:8192
    v_dot2_f32_bf16 v136, v80, v129, v132
    v_dot2_f32_bf16 v137, v80, v130, v132
    v_dot2_f32_bf16 v138, v81, v129, v132
    v_dot2_f32_bf16 v139, v81, v130, v132
    v_dot2_f32_bf16 v140, v82, v129, v132
    v_dot2_f32_bf16 v141, v82, v130, v132
    v_dot2_f32_bf16 v142, v83, v129, v132
    v_dot2_f32_bf16 v143, v83, v130, v132
    v_cvt_pk_bf16_f32 v76, v144, v145
    v_cvt_pk_bf16_f32 v77, v146, v147
    v_cvt_pk_bf16_f32 v78, v148, v149
    v_cvt_pk_bf16_f32 v79, v150, v151
    ds_write_b128 v9, v[76:79] offset:12288
    v_dot2_f32_bf16 v144, v84, v129, v132
    v_dot2_f32_bf16 v145, v84, v130, v132
    v_dot2_f32_bf16 v146, v85, v129, v132
    v_dot2_f32_bf16 v147, v85, v130, v132
    v_dot2_f32_bf16 v148, v86, v129, v132
    v_dot2_f32_bf16 v149, v86, v130, v132
    v_dot2_f32_bf16 v150, v87, v129, v132
    v_dot2_f32_bf16 v151, v87, v130, v132
    v_cvt_pk_bf16_f32 v80, v136, v137
    v_cvt_pk_bf16_f32 v81, v138, v139
    v_cvt_pk_bf16_f32 v82, v140, v141
    v_cvt_pk_bf16_f32 v83, v142, v143
    ds_write_b128 v9, v[80:83] offset:16384
    v_dot2_f32_bf16 v136, v88, v129, v132
    v_dot2_f32_bf16 v137, v88, v130, v132
    v_dot2_f32_bf16 v138, v89, v129, v132
    v_dot2_f32_bf16 v139, v89, v130, v132
    v_dot2_f32_bf16 v140, v90, v129, v132
    v_dot2_f32_bf16 v141, v90, v130, v132
    v_dot2_f32_bf16 v142, v91, v129, v132
    v_dot2_f32_bf16 v143, v91, v130, v132
    v_cvt_pk_bf16_f32 v84, v144, v145
    v_cvt_pk_bf16_f32 v85, v146, v147
    v_cvt_pk_bf16_f32 v86, v148, v149
    v_cvt_pk_bf16_f32 v87, v150, v151
    ds_write_b128 v9, v[84:87] offset:20480
    v_dot2_f32_bf16 v144, v92, v129, v132
    v_dot2_f32_bf16 v145, v92, v130, v132
    v_dot2_f32_bf16 v146, v93, v129, v132
    v_dot2_f32_bf16 v147, v93, v130, v132
    v_dot2_f32_bf16 v148, v94, v129, v132
    v_dot2_f32_bf16 v149, v94, v130, v132
    v_dot2_f32_bf16 v150, v95, v129, v132
    v_dot2_f32_bf16 v151, v95, v130, v132
    v_cvt_pk_bf16_f32 v88, v136, v137
    v_cvt_pk_bf16_f32 v89, v138, v139
    v_cvt_pk_bf16_f32 v90, v140, v141
    v_cvt_pk_bf16_f32 v91, v142, v143
    ds_write_b128 v9, v[88:91] offset:24576
    v_fma_f32 v134, -v132, v132, v134
    v_max_f32 v134, 0, v134
    v_add_f32 v134, 0x3727c5ac, v134
    v_rsq_f32 v134, v134
    v_cvt_pk_bf16_f32 v92, v144, v145
    v_cvt_pk_bf16_f32 v93, v146, v147
    v_cvt_pk_bf16_f32 v94, v148, v149
    v_cvt_pk_bf16_f32 v95, v150, v151
    ds_write_b128 v9, v[92:95] offset:28672
    ds_write_b32 v10, v134
    s_waitcnt lgkmcnt(0)
    s_cmp_ge_u32 s28, 4
    s_cbranch_scc1 LhiA_1
    s_barrier
    ds_read_b32 v131, v13
    ds_read_b128 v[136:139], v14 offset:0
    ds_read_b128 v[140:143], v14 offset:32
    ds_read_b128 v[144:147], v14 offset:64
    ds_read_b128 v[148:151], v14 offset:96
    ds_read_b128 v[64:67], v4 offset:0
    ds_read_b64_tr_b16 v[72:73], v12 offset:1024
    ds_read_b64_tr_b16 v[74:75], v12 offset:1536
    ds_read_b64_tr_b16 v[76:77], v12 offset:2048
    ds_read_b64_tr_b16 v[78:79], v12 offset:2560
    ds_read_b128 v[80:83], v5 offset:1024
    ds_read_b64_tr_b16 v[88:89], v12 offset:7168
    ds_read_b64_tr_b16 v[90:91], v12 offset:7680
    ds_read_b64_tr_b16 v[92:93], v12 offset:8192
    ds_read_b64_tr_b16 v[94:95], v12 offset:8704
    s_mov_b32 s34, 7
Lcl_3:
    s_waitcnt lgkmcnt(0)
    v_mfma_f32_32x32x16_bf16 v[32:47], v[72:75], v[64:67], v[32:47]
    ds_read_b128 v[96:99], v6 offset:2048
    ds_read_b64_tr_b16 v[104:105], v12 offset:13312
    ds_read_b64_tr_b16 v[106:107], v12 offset:13824
    ds_read_b64_tr_b16 v[108:109], v12 offset:14336
    v_mfma_f32_32x32x16_bf16 v[48:63], v[64:67], v[76:79], v[48:63]
    ds_read_b64_tr_b16 v[110:111], v12 offset:14848
    ds_read_b128 v[112:115], v7 offset:3072
    ds_read_b64_tr_b16 v[120:121], v12 offset:19456
    v_mfma_f32_32x32x16_bf16 v[32:47], v[88:91], v[80:83], v[32:47]
    ds_read_b64_tr_b16 v[122:123], v12 offset:19968
    ds_read_b64_tr_b16 v[124:125], v12 offset:20480
    ds_read_b64_tr_b16 v[126:127], v12 offset:20992
    v_mfma_f32_32x32x16_bf16 v[48:63], v[80:83], v[92:95], v[48:63]
    s_add_u32 s35, s35, 24576
    s_cmp_eq_u32 s35, 98304
    s_cselect_b32 s35, 0, s35
    v_add_u32 v4, 4096, v4
    v_add_u32 v5, 4096, v5
    v_add_u32 v6, 4096, v6
    v_add_u32 v7, 4096, v7
    v_add_u32 v12, s35, v11
    s_sub_u32 s34, s34, 1
    s_waitcnt lgkmcnt(0)
    s_barrier
    v_mfma_f32_32x32x16_bf16 v[32:47], v[104:107], v[96:99], v[32:47]
    ds_read_b128 v[64:67], v4 offset:0
    ds_read_b64_tr_b16 v[72:73], v12 offset:1024
    ds_read_b64_tr_b16 v[74:75], v12 offset:1536
    ds_read_b64_tr_b16 v[76:77], v12 offset:2048
    v_mfma_f32_32x32x16_bf16 v[48:63], v[96:99], v[108:111], v[48:63]
    ds_read_b64_tr_b16 v[78:79], v12 offset:2560
    ds_read_b128 v[80:83], v5 offset:1024
    ds_read_b64_tr_b16 v[88:89], v12 offset:7168
    v_mfma_f32_32x32x16_bf16 v[32:47], v[120:123], v[112:115], v[32:47]
    ds_read_b64_tr_b16 v[90:91], v12 offset:7680
    ds_read_b64_tr_b16 v[92:93], v12 offset:8192
    ds_read_b64_tr_b16 v[94:95], v12 offset:8704
    v_mfma_f32_32x32x16_bf16 v[48:63], v[112:115], v[124:127], v[48:63]
    s_cmp_lg_u32 s34, 0
    s_cbranch_scc1 Lcl_3
    s_waitcnt lgkmcnt(0)
    v_mfma_f32_32x32x16_bf16 v[32:47], v[72:75], v[64:67], v[32:47]
    ds_read_b128 v[96:99], v6 offset:2048
    ds_read_b64_tr_b16 v[104:105], v12 offset:13312
    ds_read_b64_tr_b16 v[106:107], v12 offset:13824
    ds_read_b64_tr_b16 v[108:109], v12 offset:14336
    v_mfma_f32_32x32x16_bf16 v[48:63], v[64:67], v[76:79], v[48:63]
    ds_read_b64_tr_b16 v[110:111], v12 offset:14848
    ds_read_b128 v[112:115], v7 offset:3072
    ds_read_b64_tr_b16 v[120:121], v12 offset:19456
    v_mfma_f32_32x32x16_bf16 v[32:47], v[88:91], v[80:83], v[32:47]
    ds_read_b64_tr_b16 v[122:123], v12 offset:19968
    ds_read_b64_tr_b16 v[124:125], v12 offset:20480
    ds_read_b64_tr_b16 v[126:127], v12 offset:20992
    v_mfma_f32_32x32x16_bf16 v[48:63], v[80:83], v[92:95], v[48:63]
    s_waitcnt lgkmcnt(5)
    v_mfma_f32_32x32x16_bf16 v[32:47], v[104:107], v[96:99], v[32:47]
    v_mfma_f32_32x32x16_bf16 v[48:63], v[96:99], v[108:111], v[48:63]
    s_waitcnt lgkmcnt(0)
    v_mfma_f32_32x32x16_bf16 v[32:47], v[120:123], v[112:115], v[32:47]
    v_mfma_f32_32x32x16_bf16 v[48:63], v[112:115], v[124:127], v[48:63]
    s_nop 10
    v_mul_f32 v32, v32, v131
    v_mul_f32 v33, v33, v131
    v_mul_f32 v34, v34, v131
    v_mul_f32 v35, v35, v131
    v_mul_f32 v36, v36, v131
    v_mul_f32 v37, v37, v131
    v_mul_f32 v38, v38, v131
    v_mul_f32 v39, v39, v131
    v_cvt_pk_bf16_f32 v64, v32, v33
    v_cvt_pk_bf16_f32 v65, v34, v35
    v_cvt_pk_bf16_f32 v66, v36, v37
    v_cvt_pk_bf16_f32 v67, v38, v39
    buffer_store_dwordx4 v[64:67], v2, s[12:15], s37 offen  sc1
    v_mul_f32 v40, v40, v131
    v_mul_f32 v41, v41, v131
    v_mul_f32 v42, v42, v131
    v_mul_f32 v43, v43, v131
    v_mul_f32 v44, v44, v131
    v_mul_f32 v45, v45, v131
    v_mul_f32 v46, v46, v131
    v_mul_f32 v47, v47, v131
    v_cvt_pk_bf16_f32 v68, v40, v41
    v_cvt_pk_bf16_f32 v69, v42, v43
    v_cvt_pk_bf16_f32 v70, v44, v45
    v_cvt_pk_bf16_f32 v71, v46, v47
    buffer_store_dwordx4 v[68:71], v2, s[12:15], s38 offen  sc1
    v_mul_f32 v48, v48, v136
    v_mul_f32 v49, v49, v137
    v_mul_f32 v50, v50, v138
    v_mul_f32 v51, v51, v139
    v_mul_f32 v52, v52, v140
    v_mul_f32 v53, v53, v141
    v_mul_f32 v54, v54, v142
    v_mul_f32 v55, v55, v143
    v_cvt_pk_bf16_f32 v72, v48, v49
    v_cvt_pk_bf16_f32 v73, v50, v51
    v_cvt_pk_bf16_f32 v74, v52, v53
    v_cvt_pk_bf16_f32 v75, v54, v55
    buffer_store_dwordx4 v[72:75], v15, s[12:15], s37 offen offset:1024 sc1
    v_mul_f32 v56, v56, v144
    v_mul_f32 v57, v57, v145
    v_mul_f32 v58, v58, v146
    v_mul_f32 v59, v59, v147
    v_mul_f32 v60, v60, v148
    v_mul_f32 v61, v61, v149
    v_mul_f32 v62, v62, v150
    v_mul_f32 v63, v63, v151
    v_cvt_pk_bf16_f32 v76, v56, v57
    v_cvt_pk_bf16_f32 v77, v58, v59
    v_cvt_pk_bf16_f32 v78, v60, v61
    v_cvt_pk_bf16_f32 v79, v62, v63
    buffer_store_dwordx4 v[76:79], v15, s[12:15], s37 offen offset:1536 sc1
    s_branch LendA_2
LhiA_1:
    s_mov_b32 s16, s80
    s_mov_b32 s17, s81
    s_mov_b32 s18, 256
    s_mov_b32 s19, 0x00020000
    v_mov_b32 v10, 0
    s_cmp_lg_u32 s28, 7
    s_cbranch_scc1 Lnn_4
    s_cmp_lg_u32 s2, 0
    s_cbranch_scc1 Lnn_4
    s_memrealtime s[84:85]
    s_waitcnt lgkmcnt(0)
    s_or_b32 s84, s84, 1
    v_mov_b32 v8, s84
    v_mov_b32 v9, s85
    s_mov_b64 exec, 1
    buffer_store_dwordx2 v[8:9], v10, s[16:19], 0 offen sc1
    s_mov_b64 exec, -1
Lnn_4:
    s_barrier
    ds_read_b32 v131, v13
    ds_read_b128 v[64:67], v4 offset:0
    ds_read_b64_tr_b16 v[68:69], v12 offset:0
    ds_read_b64_tr_b16 v[70:71], v12 offset:512
    ds_read_b128 v[80:83], v5 offset:1024
    ds_read_b64_tr_b16 v[84:85], v12 offset:6144
    ds_read_b64_tr_b16 v[86:87], v12 offset:6656
    s_mov_b32 s34, 3
Lcl_7:
    s_waitcnt lgkmcnt(0)
    v_mfma_f32_32x32x16_bf16 v[16:31], v[68:71], v[64:67], v[16:31]
    ds_read_b128 v[96:99], v6 offset:2048
    ds_read_b64_tr_b16 v[100:101], v12 offset:12288
    ds_read_b64_tr_b16 v[102:103], v12 offset:12800
    ds_read_b128 v[112:115], v7 offset:3072
    ds_read_b64_tr_b16 v[116:117], v12 offset:18432
    ds_read_b64_tr_b16 v[118:119], v12 offset:18944
    v_mfma_f32_32x32x16_bf16 v[16:31], v[84:87], v[80:83], v[16:31]
    s_add_u32 s35, s35, 24576
    s_cmp_eq_u32 s35, 98304
    s_cselect_b32 s35, 0, s35
    v_add_u32 v4, 4096, v4
    v_add_u32 v5, 4096, v5
    v_add_u32 v6, 4096, v6
    v_add_u32 v7, 4096, v7
    v_add_u32 v12, s35, v11
    s_sub_u32 s34, s34, 1
    s_waitcnt lgkmcnt(0)
    s_barrier
    v_mfma_f32_32x32x16_bf16 v[16:31], v[100:103], v[96:99], v[16:31]
    ds_read_b128 v[64:67], v4 offset:0
    ds_read_b64_tr_b16 v[68:69], v12 offset:0
    ds_read_b64_tr_b16 v[70:71], v12 offset:512
    ds_read_b128 v[80:83], v5 offset:1024
    ds_read_b64_tr_b16 v[84:85], v12 offset:6144
    ds_read_b64_tr_b16 v[86:87], v12 offset:6656
    v_mfma_f32_32x32x16_bf16 v[16:31], v[116:119], v[112:115], v[16:31]
    s_cmp_lg_u32 s34, 0
    s_cbranch_scc1 Lcl_7
    s_waitcnt lgkmcnt(0)
    v_mfma_f32_32x32x16_bf16 v[16:31], v[68:71], v[64:67], v[16:31]
    ds_read_b128 v[96:99], v6 offset:2048
    ds_read_b64_tr_b16 v[100:101], v12 offset:12288
    ds_read_b64_tr_b16 v[102:103], v12 offset:12800
    ds_read_b128 v[112:115], v7 offset:3072
    ds_read_b64_tr_b16 v[116:117], v12 offset:18432
    ds_read_b64_tr_b16 v[118:119], v12 offset:18944
    v_mfma_f32_32x32x16_bf16 v[16:31], v[84:87], v[80:83], v[16:31]
    s_waitcnt lgkmcnt(3)
    v_mfma_f32_32x32x16_bf16 v[16:31], v[100:103], v[96:99], v[16:31]
    s_waitcnt lgkmcnt(0)
    v_mfma_f32_32x32x16_bf16 v[16:31], v[116:119], v[112:115], v[16:31]
    s_add_u32 s35, s35, 24576
    s_cmp_eq_u32 s35, 98304
    s_cselect_b32 s35, 0, s35
    v_add_u32 v4, 4096, v4
    v_add_u32 v5, 4096, v5
    v_add_u32 v6, 4096, v6
    v_add_u32 v7, 4096, v7
    v_add_u32 v12, s35, v11
    v_mul_f32 v131, 0x3eb8aa3b, v131
    s_mov_b32 s34, 4
Lidle_8:
    s_barrier
    s_sub_u32 s34, s34, 1
    s_cmp_lg_u32 s34, 0
    s_cbranch_scc1 Lidle_8
    s_cmp_lg_u32 s28, 7
    s_cbranch_scc1 Ltg_9
    buffer_load_dwordx2 v[8:9], v10, s[16:19], 0 offen sc1
Ltg_9:
    ds_read_b128 v[64:67], v4 offset:0
    ds_read_b64_tr_b16 v[68:69], v12 offset:0
    ds_read_b64_tr_b16 v[70:71], v12 offset:512
    ds_read_b128 v[80:83], v5 offset:1024
    ds_read_b64_tr_b16 v[84:85], v12 offset:6144
    ds_read_b64_tr_b16 v[86:87], v12 offset:6656
    s_mov_b32 s34, 3
Lcl_10:
    s_waitcnt lgkmcnt(0)
    v_mfma_f32_32x32x16_bf16 v[16:31], v[68:71], v[64:67], v[16:31]
    ds_read_b128 v[96:99], v6 offset:2048
    ds_read_b64_tr_b16 v[100:101], v12 offset:12288
    ds_read_b64_tr_b16 v[102:103], v12 offset:12800
    ds_read_b128 v[112:115], v7 offset:3072
    ds_read_b64_tr_b16 v[116:117], v12 offset:18432
    ds_read_b64_tr_b16 v[118:119], v12 offset:18944
    v_mfma_f32_32x32x16_bf16 v[16:31], v[84:87], v[80:83], v[16:31]
    s_add_u32 s35, s35, 24576
    s_cmp_eq_u32 s35, 98304
    s_cselect_b32 s35, 0, s35
    v_add_u32 v4, 4096, v4
    v_add_u32 v5, 4096, v5
    v_add_u32 v6, 4096, v6
    v_add_u32 v7, 4096, v7
    v_add_u32 v12, s35, v11
    s_sub_u32 s34, s34, 1
    s_waitcnt lgkmcnt(0)
    v_mfma_f32_32x32x16_bf16 v[16:31], v[100:103], v[96:99], v[16:31]
    ds_read_b128 v[64:67], v4 offset:0
    ds_read_b64_tr_b16 v[68:69], v12 offset:0
    ds_read_b64_tr_b16 v[70:71], v12 offset:512
    ds_read_b128 v[80:83], v5 offset:1024
    ds_read_b64_tr_b16 v[84:85], v12 offset:6144
    ds_read_b64_tr_b16 v[86:87], v12 offset:6656
    v_mfma_f32_32x32x16_bf16 v[16:31], v[116:119], v[112:115], v[16:31]
    s_cmp_lg_u32 s34, 0
    s_cbranch_scc1 Lcl_10
    s_waitcnt lgkmcnt(0)
    v_mfma_f32_32x32x16_bf16 v[16:31], v[68:71], v[64:67], v[16:31]
    ds_read_b128 v[96:99], v6 offset:2048
    ds_read_b64_tr_b16 v[100:101], v12 offset:12288
    ds_read_b64_tr_b16 v[102:103], v12 offset:12800
    ds_read_b128 v[112:115], v7 offset:3072
    ds_read_b64_tr_b16 v[116:117], v12 offset:18432
    ds_read_b64_tr_b16 v[118:119], v12 offset:18944
    v_mfma_f32_32x32x16_bf16 v[16:31], v[84:87], v[80:83], v[16:31]
    s_waitcnt lgkmcnt(3)
    v_mfma_f32_32x32x16_bf16 v[16:31], v[100:103], v[96:99], v[16:31]
    s_waitcnt lgkmcnt(0)
    v_mfma_f32_32x32x16_bf16 v[16:31], v[116:119], v[112:115], v[16:31]
    s_nop 11
    v_mul_f32 v16, v16, v131
    v_mul_f32 v17, v17, v131
    v_mul_f32 v18, v18, v131
    v_mul_f32 v19, v19, v131
    v_mul_f32 v20, v20, v131
    v_mul_f32 v21, v21, v131
    v_mul_f32 v22, v22, v131
    v_mul_f32 v23, v23, v131
    v_cvt_pk_bf16_f32 v64, v16, v17
    v_cvt_pk_bf16_f32 v65, v18, v19
    v_cvt_pk_bf16_f32 v66, v20, v21
    v_cvt_pk_bf16_f32 v67, v22, v23
    buffer_store_dwordx4 v[64:67], v2, s[12:15], s39 offen  sc1
    v_mul_f32 v24, v24, v131
    v_mul_f32 v25, v25, v131
    v_mul_f32 v26, v26, v131
    v_mul_f32 v27, v27, v131
    v_mul_f32 v28, v28, v131
    v_mul_f32 v29, v29, v131
    v_mul_f32 v30, v30, v131
    v_mul_f32 v31, v31, v131
    v_cvt_pk_bf16_f32 v68, v24, v25
    v_cvt_pk_bf16_f32 v69, v26, v27
    v_cvt_pk_bf16_f32 v70, v28, v29
    v_cvt_pk_bf16_f32 v71, v30, v31
    buffer_store_dwordx4 v[68:71], v2, s[12:15], s36 offen  sc1
    s_cmp_lg_u32 s28, 7
    s_cbranch_scc1 LendA_2
    s_mov_b32 s45, 30000
    s_waitcnt vmcnt(2)
Ltp_5:
    v_readfirstlane_b32 s84, v8
    v_readfirstlane_b32 s85, v9
    s_nop 3
    s_cmp_lg_u32 s84, 0
    s_cbranch_scc1 LendA_2
    buffer_load_dwordx2 v[8:9], v10, s[16:19], 0 offen sc1
    s_waitcnt vmcnt(0)
    s_sub_u32 s45, s45, 1
    s_cmp_lg_u32 s45, 0
    s_cbranch_scc1 Ltp_5
LendA_2:
    s_cmp_lg_u32 s28, 7
    s_cbranch_scc1 Lna_11
    s_lshl_b32 s46, s57, 5
    s_add_u32 s46, s46, s56
    s_lshr_b32 s47, s24, 2
    s_lshl_b32 s47, s47, 5
    s_lshl_b32 s44, s47, 7
    s_add_u32 s44, s44, 11534336
    v_lshlrev_b32 v6, 7, v0
    s_mov_b32 s48, 0xffffffff
    s_mov_b32 s49, 0
    s_lshl_b32 s46, s46, 7
    s_add_u32 s46, s46, 11534336
    v_mov_b32 v4, s84
    v_mov_b32 v5, s85
    v_mov_b32 v7, 0
Lna_11:
    s_waitcnt vmcnt(0)
    s_cmp_lg_u32 s28, 7
    s_barrier
    s_cbranch_scc1 Lns_12
    s_mov_b64 exec, 1
    buffer_store_dwordx2 v[4:5], v7, s[12:15], s46 offen sc1
    s_mov_b64 exec, -1
Lns_12:
    s_barrier
    s_lshl_b32 s29, s25, 3
    s_add_u32 s29, s29, s28
    s_lshl_b32 s30, s24, 16
    s_lshl_b32 s31, s29, 10
    s_add_u32 s30, s30, s31
    s_add_u32 s30, s30, 0
    s_lshl_b32 s43, s24, 17
    s_add_u32 s43, s43, 2097152
    v_and_b32 v114, 11, v0
    v_cmp_eq_u32 vcc, 0, v114
    v_mov_b32 v115, 0x3f803f80
    s_lshl_b32 s31, s28, 10
    s_add_u32 s31, s31, 131072
    v_cndmask_b32 v80, 0, v115, vcc
    v_add_u32 v114, s31, v2
    v_mov_b32 v81, v80
    v_mov_b32 v82, v80
    v_mov_b32 v83, v80
    ds_write_b128 v114, v[80:83]
    ds_write_b128 v114, v[80:83] offset:2048
    v_and_b32 v118, 15, v0
    v_lshlrev_b32 v118, 4, v118
    v_lshl_add_u32 v118, v1, 8, v118
    v_and_b32 v114, 16, v0
    v_cmp_eq_u32 vcc, 0, v114
    v_mov_b32 v114, 131072
    v_mov_b32 v115, 1024
    v_mov_b32 v116, 8192
    v_cndmask_b32 v114, v114, v115, vcc
    v_cndmask_b32 v119, 0, v116, vcc
    v_add_u32 v118, v118, v114
    v_mov_b32 v120, 157696
    s_mov_b32 s40, 0x400000
    s_mov_b32 s36, 0
    s_lshl_b32 s29, s29, 15
    s_lshl_b32 s31, s24, 10
    s_add_u32 s29, s29, s31
    s_add_u32 s29, s29, 6291456
    s_setprio 1
    s_cmp_lt_u32 s28, 4
    s_cbranch_scc1 Lpr_14
    s_setprio 2
Lpr_14:
    v_mov_b32 v64, 0
    v_mov_b32 v65, 0
    v_mov_b32 v66, 0
    v_mov_b32 v67, 0
    v_mov_b32 v68, 0
    v_mov_b32 v69, 0
    v_mov_b32 v70, 0
    v_mov_b32 v71, 0
    v_mov_b32 v72, 0
    v_mov_b32 v73, 0
    v_mov_b32 v74, 0
    v_mov_b32 v75, 0
    v_mov_b32 v76, 0
    v_mov_b32 v77, 0
    v_mov_b32 v78, 0
    v_mov_b32 v79, 0
    v_mov_b32 v44, 0
    v_mov_b32 v36, 0
    v_mov_b32 v45, 0
    v_mov_b32 v37, 0
    v_mov_b32 v46, 0
    v_mov_b32 v38, 0
    v_mov_b32 v47, 0
    v_mov_b32 v39, 0
    s_waitcnt lgkmcnt(0)
    s_cmp_lg_u32 s28, 7
    s_cbranch_scc1 Lnp_13
    s_mov_b64 exec, s[48:49]
    buffer_load_dwordx2 v[8:9], v6, s[12:15], s44 offen sc1
    s_mov_b64 exec, -1
    s_mov_b32 s45, 30000
    s_mov_b64 exec, s[48:49]
Lpoll_15:
    s_waitcnt vmcnt(0)
    v_cmp_ne_u64 vcc, s[84:85], v[8:9]
    s_cbranch_vccz Lpolld_16
    s_mov_b64 exec, vcc
    buffer_load_dwordx2 v[8:9], v6, s[12:15], s44 offen sc1
    s_sub_u32 s45, s45, 1
    s_cmp_lg_u32 s45, 0
    s_cbranch_scc1 Lpoll_15
Lpolld_16:
    s_mov_b64 exec, -1
Lnp_13:
    s_barrier
    buffer_load_dwordx4 v[12:15], v2, s[12:15], s30 offen sc1
    buffer_load_dwordx4 v[16:19], v2, s[12:15], s43 offen sc1
    s_waitcnt vmcnt(0)
    v_mfma_f32_32x32x16_bf16 v[80:95], v[16:19], v[12:15], 0
    s_nop 15
    v_max3_f32 v112, v80, v81, v82
    v_max_f32 v112, v112, v83
    v_max3_f32 v112, v112, v84, v85
    v_max3_f32 v112, v112, v86, v87
    v_max3_f32 v112, v112, v88, v89
    v_max3_f32 v112, v112, v90, v91
    v_max3_f32 v112, v112, v92, v93
    v_max3_f32 v112, v112, v94, v95
Lhave_17:
    v_mov_b32 v114, v112
    v_mov_b32 v10, v2
    v_mov_b32 v11, v118
    v_permlane32_swap_b32 v112, v114
    s_mov_b32 s37, 0
    s_mov_b32 s42, 3
    v_max_f32 v112, v112, v114
    v_sub_f32 v48, 0, v112
    v_sub_f32 v49, 0, v112
    v_sub_f32 v50, 0, v112
    v_sub_f32 v51, 0, v112
    v_sub_f32 v52, 0, v112
    v_sub_f32 v53, 0, v112
    v_sub_f32 v54, 0, v112
    v_sub_f32 v55, 0, v112
    v_sub_f32 v56, 0, v112
    v_sub_f32 v57, 0, v112
    v_sub_f32 v58, 0, v112
    v_sub_f32 v59, 0, v112
    v_sub_f32 v60, 0, v112
    v_sub_f32 v61, 0, v112
    v_sub_f32 v62, 0, v112
    v_sub_f32 v63, 0, v112
    s_nop 1
    v_mfma_f32_32x32x16_bf16 v[80:95], v[16:19], v[12:15], v[48:63]
Lsp_24:
    ds_read_b128 v[124:127], v120
    s_sub_u32 s40, s40, 1
    s_cbranch_scc1 Lexit
    s_waitcnt lgkmcnt(0)
    v_min3_u32 v121, v124, v125, v126
    v_min_u32 v121, v121, v127
    v_cmp_gt_u32 vcc, 1, v121
    s_cbranch_vccnz Lsp_24
    ds_read_b128 v[20:23], v10 offset:2048
    ds_read_b128 v[24:27], v11
    ds_read_b128 v[28:31], v11 offset:512
Lcp_25:
Lsp_26:
    ds_read_b128 v[124:127], v120
    s_sub_u32 s40, s40, 1
    s_cbranch_scc1 Lexit
    s_waitcnt lgkmcnt(0)
    v_min3_u32 v121, v124, v125, v126
    v_min_u32 v121, v121, v127
    v_cmp_gt_u32 vcc, s42, v121
    s_cbranch_vccnz Lsp_26
    v_readfirstlane_b32 s38, v121
    s_mov_b32 s41, 0
    s_add_u32 s43, s37, 1
    s_max_u32 s43, s43, 12
    s_sub_u32 s39, s38, 1
    s_lshr_b32 s39, s39, 1
    s_min_u32 s39, s39, s43
    s_lshl_b32 s42, s39, 1
    s_add_u32 s42, s42, 3
    s_min_u32 s42, s42, 32
    s_cmp_ge_u32 s38, 32
    s_cselect_b32 s39, s43, s39
    s_cselect_b32 s41, 1, 0
Laloop_19:
    s_waitcnt lgkmcnt(0)
    v_mfma_f32_32x32x16_bf16 v[96:111], v[20:23], v[12:15], v[48:63]
    v_exp_f32 v80, v80
    v_exp_f32 v81, v81
    v_exp_f32 v82, v82
    v_exp_f32 v83, v83
    v_mfma_f32_32x32x16_bf16 v[64:79], v[36:39], v[44:47], v[64:79]
    ds_read_b128 v[16:19], v10 offset:4096
    ds_read_b128 v[32:35], v11 offset:2048
    ds_read_b128 v[36:39], v11 offset:2560
    v_exp_f32 v84, v84
    v_exp_f32 v85, v85
    v_exp_f32 v86, v86
    v_exp_f32 v87, v87
    v_cvt_pk_bf16_f32 v40, v80, v81
    v_cvt_pk_bf16_f32 v41, v82, v83
    v_cvt_pk_bf16_f32 v42, v84, v85
    v_cvt_pk_bf16_f32 v43, v86, v87
    v_exp_f32 v88, v88
    v_exp_f32 v89, v89
    v_mfma_f32_32x32x16_bf16 v[64:79], v[24:27], v[40:43], v[64:79]
    v_exp_f32 v90, v90
    v_exp_f32 v91, v91
    v_exp_f32 v92, v92
    v_exp_f32 v93, v93
    v_exp_f32 v94, v94
    v_exp_f32 v95, v95
    v_cvt_pk_bf16_f32 v44, v88, v89
    v_cvt_pk_bf16_f32 v45, v90, v91
    v_cvt_pk_bf16_f32 v46, v92, v93
    v_cvt_pk_bf16_f32 v47, v94, v95
    s_waitcnt lgkmcnt(0)
    v_mfma_f32_32x32x16_bf16 v[80:95], v[16:19], v[12:15], v[48:63]
    v_exp_f32 v96, v96
    v_exp_f32 v97, v97
    v_exp_f32 v98, v98
    v_exp_f32 v99, v99
    v_mfma_f32_32x32x16_bf16 v[64:79], v[28:31], v[44:47], v[64:79]
    ds_read_b128 v[20:23], v10 offset:6144
    ds_read_b128 v[24:27], v11 offset:4096
    ds_read_b128 v[28:31], v11 offset:4608
    v_exp_f32 v100, v100
    v_exp_f32 v101, v101
    v_exp_f32 v102, v102
    v_exp_f32 v103, v103
    v_cvt_pk_bf16_f32 v40, v96, v97
    v_cvt_pk_bf16_f32 v41, v98, v99
    v_cvt_pk_bf16_f32 v42, v100, v101
    v_cvt_pk_bf16_f32 v43, v102, v103
    v_exp_f32 v104, v104
    v_exp_f32 v105, v105
    v_mfma_f32_32x32x16_bf16 v[64:79], v[32:35], v[40:43], v[64:79]
    v_exp_f32 v106, v106
    v_exp_f32 v107, v107
    v_exp_f32 v108, v108
    v_exp_f32 v109, v109
    v_exp_f32 v110, v110
    v_exp_f32 v111, v111
    v_cvt_pk_bf16_f32 v44, v104, v105
    v_cvt_pk_bf16_f32 v45, v106, v107
    v_cvt_pk_bf16_f32 v46, v108, v109
    v_cvt_pk_bf16_f32 v47, v110, v111
    s_waitcnt lgkmcnt(0)
    v_mfma_f32_32x32x16_bf16 v[96:111], v[20:23], v[12:15], v[48:63]
    v_exp_f32 v80, v80
    v_exp_f32 v81, v81
    v_exp_f32 v82, v82
    v_exp_f32 v83, v83
    v_mfma_f32_32x32x16_bf16 v[64:79], v[36:39], v[44:47], v[64:79]
    ds_read_b128 v[16:19], v10 offset:8192
    ds_read_b128 v[32:35], v11 offset:6144
    ds_read_b128 v[36:39], v11 offset:6656
    v_exp_f32 v84, v84
    v_exp_f32 v85, v85
    v_exp_f32 v86, v86
    v_exp_f32 v87, v87
    v_cvt_pk_bf16_f32 v40, v80, v81
    v_cvt_pk_bf16_f32 v41, v82, v83
    v_cvt_pk_bf16_f32 v42, v84, v85
    v_cvt_pk_bf16_f32 v43, v86, v87
    v_exp_f32 v88, v88
    v_exp_f32 v89, v89
    v_mfma_f32_32x32x16_bf16 v[64:79], v[24:27], v[40:43], v[64:79]
    v_exp_f32 v90, v90
    v_exp_f32 v91, v91
    v_exp_f32 v92, v92
    v_exp_f32 v93, v93
    v_exp_f32 v94, v94
    v_exp_f32 v95, v95
    v_cvt_pk_bf16_f32 v44, v88, v89
    v_cvt_pk_bf16_f32 v45, v90, v91
    v_cvt_pk_bf16_f32 v46, v92, v93
    v_cvt_pk_bf16_f32 v47, v94, v95
    s_waitcnt lgkmcnt(0)
    v_mfma_f32_32x32x16_bf16 v[80:95], v[16:19], v[12:15], v[48:63]
    v_exp_f32 v96, v96
    v_exp_f32 v97, v97
    v_exp_f32 v98, v98
    v_exp_f32 v99, v99
    v_mfma_f32_32x32x16_bf16 v[64:79], v[28:31], v[44:47], v[64:79]
    ds_read_b128 v[20:23], v10 offset:10240
    ds_read_b128 v[24:27], v11 offset:8192
    ds_read_b128 v[28:31], v11 offset:8704
    v_exp_f32 v100, v100
    v_exp_f32 v101, v101
    v_exp_f32 v102, v102
    v_exp_f32 v103, v103
    v_cvt_pk_bf16_f32 v40, v96, v97
    v_cvt_pk_bf16_f32 v41, v98, v99
    v_cvt_pk_bf16_f32 v42, v100, v101
    v_cvt_pk_bf16_f32 v43, v102, v103
    v_exp_f32 v104, v104
    v_exp_f32 v105, v105
    v_mfma_f32_32x32x16_bf16 v[64:79], v[32:35], v[40:43], v[64:79]
    s_add_u32 s37, s37, 1
    s_cmp_lt_u32 s37, s39
    v_exp_f32 v106, v106
    v_exp_f32 v107, v107
    v_exp_f32 v108, v108
    v_exp_f32 v109, v109
    v_exp_f32 v110, v110
    v_exp_f32 v111, v111
    v_add_u32 v10, 8192, v10
    v_add_u32 v11, v119, v11
    v_cvt_pk_bf16_f32 v44, v104, v105
    v_cvt_pk_bf16_f32 v45, v106, v107
    v_cvt_pk_bf16_f32 v46, v108, v109
    v_cvt_pk_bf16_f32 v47, v110, v111
    s_cbranch_scc1 Laloop_19
    s_cmp_eq_u32 s37, 16
    s_cbranch_scc1 Ladone_21
    s_cmp_eq_u32 s41, 0
    s_cbranch_scc1 Lcp_25
Lswp_20:
    s_mov_b32 s39, 16
    s_cmp_lt_u32 s28, 4
    s_cbranch_scc1 Laloop_19
    s_setprio 0
    s_branch Laloop_19
Ladone_21:
    v_mfma_f32_32x32x16_bf16 v[64:79], v[36:39], v[44:47], v[64:79]
    s_waitcnt lgkmcnt(0)
    s_mov_b32 s38, 0x4f800000
    s_nop 13
    v_cmp_nlt_f32 vcc, v72, s38
    v_rcp_f32 v116, v72
    s_cmp_lg_u32 s36, 0
    s_cbranch_scc1 Lafin_23
    s_cbranch_vccz Lafin_23
    s_mov_b32 s36, 1
    s_mov_b32 s37, 0
    v_mov_b32 v10, v2
    v_mov_b32 v112, 0xff800000
    v_mov_b32 v64, 0
    v_mov_b32 v65, 0
    v_mov_b32 v66, 0
    v_mov_b32 v67, 0
    v_mov_b32 v68, 0
    v_mov_b32 v69, 0
    v_mov_b32 v70, 0
    v_mov_b32 v71, 0
    v_mov_b32 v72, 0
    v_mov_b32 v73, 0
    v_mov_b32 v74, 0
    v_mov_b32 v75, 0
    v_mov_b32 v76, 0
    v_mov_b32 v77, 0
    v_mov_b32 v78, 0
    v_mov_b32 v79, 0
    v_mov_b32 v44, 0
    v_mov_b32 v36, 0
    v_mov_b32 v45, 0
    v_mov_b32 v37, 0
    v_mov_b32 v46, 0
    v_mov_b32 v38, 0
    v_mov_b32 v47, 0
    v_mov_b32 v39, 0
Lmaxl_22:
    ds_read_b128 v[16:19], v10
    s_waitcnt lgkmcnt(0)
    v_mfma_f32_32x32x16_bf16 v[80:95], v[16:19], v[12:15], 0
    s_nop 15
    v_max3_f32 v112, v112, v80, v81
    v_max3_f32 v112, v112, v82, v83
    v_max3_f32 v112, v112, v84, v85
    v_max3_f32 v112, v112, v86, v87
    v_max3_f32 v112, v112, v88, v89
    v_max3_f32 v112, v112, v90, v91
    v_max3_f32 v112, v112, v92, v93
    v_max3_f32 v112, v112, v94, v95
    v_add_u32 v10, 2048, v10
    s_add_u32 s37, s37, 1
    s_cmp_lt_u32 s37, 64
    s_cbranch_scc1 Lmaxl_22
    ds_read_b128 v[16:19], v2
    s_waitcnt lgkmcnt(0)
    s_branch Lhave_17
Lafin_23:
    v_mul_f32 v64, v64, v116
    v_mul_f32 v65, v65, v116
    v_mul_f32 v66, v66, v116
    v_mul_f32 v67, v67, v116
    v_mul_f32 v68, v68, v116
    v_mul_f32 v69, v69, v116
    v_mul_f32 v70, v70, v116
    v_mul_f32 v71, v71, v116
    v_cvt_pk_bf16_f32 v40, v64, v65
    v_cvt_pk_bf16_f32 v41, v66, v67
    v_cvt_pk_bf16_f32 v42, v68, v69
    v_cvt_pk_bf16_f32 v43, v70, v71
    buffer_store_dwordx4 v[40:43], v2, s[12:15], s29 offen sc1
    s_setprio 0
    s_cmp_lg_u32 s28, 7
    s_cbranch_scc1 Lna_27
    s_lshl_b32 s46, s25, 5
    s_add_u32 s46, s46, s24
    s_lshr_b32 s47, s22, 2
    s_lshl_b32 s47, s47, 5
    s_mov_b32 s44, 11567104
    v_add_u32 v6, s47, v0
    s_lshl_b32 s45, s27, 1
    s_min_u32 s45, s45, 26
    v_bfe_u32 v7, v0, 3, 1
    v_add_u32 v7, s45, v7
    v_lshrrev_b32 v8, 2, v7
    v_lshlrev_b32 v8, 5, v8
    v_and_b32 v7, 3, v7
    v_add_u32 v8, v8, v7
    v_and_b32 v7, 7, v0
    v_lshl_add_u32 v8, v7, 2, v8
    v_cmp_lt_u32 vcc, 31, v0
    s_mov_b32 s48, -1
    s_mov_b32 s49, 0xffff
    v_cndmask_b32 v6, v6, v8, vcc
    v_lshlrev_b32 v6, 7, v6
    s_lshl_b32 s46, s46, 7
    s_add_u32 s46, s46, 11567104
    v_mov_b32 v4, s84
    v_mov_b32 v5, s85
    v_mov_b32 v7, 0
Lna_27:
    s_waitcnt vmcnt(0)
    s_cmp_lg_u32 s28, 7
    s_barrier
    s_cbranch_scc1 Lns_28
    s_mov_b64 exec, 1
    buffer_store_dwordx2 v[4:5], v7, s[12:15], s46 offen sc1
    s_mov_b64 exec, -1
Lns_28:
    s_barrier
    s_and_b32 s29, s28, 1
    s_bfe_u32 s30, s28, 0x10001
    s_lshl_b32 s31, s30, 6
    s_lshl_b32 s32, s29, 12
    v_add_u32 v10, s32, v2
    s_lshl_b32 s36, s22, 1
    s_add_u32 s36, s36, s29
    s_lshl_b32 s37, s23, 2
    s_lshl_b32 s38, s30, 1
    s_add_u32 s37, s37, s38
    v_mul_u32_u24 v11, 512, v1
    v_bfe_u32 v14, v0, 2, 2
    v_lshl_add_u32 v11, v14, 7, v11
    v_bfe_u32 v14, v0, 4, 1
    v_lshlrev_b32 v14, 5, v14
    v_and_b32 v15, 3, v0
    v_lshl_add_u32 v14, v15, 3, v14
    v_add_u32 v14, s31, v14
    v_bfe_u32 v15, v0, 3, 1
    v_lshlrev_b32 v15, 6, v15
    v_xor_b32 v14, v14, v15
    v_add_u32 v11, v11, v14
    v_add_u32 v12, 65536, v10
    v_mov_b32 v13, v11
    v_lshlrev_b32 v14, 7, v3
    v_add_u32 v14, s32, v14
    v_lshl_add_u32 v14, v1, 3, v14
    v_add_u32 v14, 149504, v14
    v_bfe_u32 v15, v0, 1, 3
    v_lshlrev_b32 v15, 4, v15
    v_xor_b32 v15, s31, v15
    v_xor_b32 v112, 0, v15
    v_add_u32 v112, v112, v14
    v_xor_b32 v113, 16, v15
    v_add_u32 v113, v113, v14
    v_xor_b32 v114, 32, v15
    v_add_u32 v114, v114, v14
    v_xor_b32 v115, 48, v15
    v_add_u32 v115, v115, v14
    s_barrier
    s_cmp_lg_u32 s28, 7
    s_cbranch_scc1 Lnp_29
    s_mov_b64 exec, s[48:49]
    buffer_load_dwordx2 v[8:9], v6, s[12:15], s44 offen sc1
    s_mov_b64 exec, -1
    s_mov_b32 s45, 30000
    s_mov_b64 exec, s[48:49]
Lpoll_30:
    s_waitcnt vmcnt(0)
    v_cmp_ne_u64 vcc, s[84:85], v[8:9]
    s_cbranch_vccz Lpolld_31
    s_mov_b64 exec, vcc
    buffer_load_dwordx2 v[8:9], v6, s[12:15], s44 offen sc1
    s_sub_u32 s45, s45, 1
    s_cmp_lg_u32 s45, 0
    s_cbranch_scc1 Lpoll_30
Lpolld_31:
    s_mov_b64 exec, -1
Lnp_29:
    s_barrier
    s_cmp_ge_u32 s28, 4
    s_cbranch_scc1 LhiC_32
    s_barrier
    ds_read_b64 v[100:101], v112
    ds_read_b64 v[102:103], v113
    ds_read_b64 v[104:105], v114
    ds_read_b64 v[106:107], v115
    s_waitcnt lgkmcnt(0)
    v_lshlrev_b32 v16, 16, v100
    v_and_b32 v17, 0xffff0000, v100
    v_lshlrev_b32 v18, 16, v101
    v_and_b32 v19, 0xffff0000, v101
    v_lshlrev_b32 v20, 16, v102
    v_and_b32 v21, 0xffff0000, v102
    v_lshlrev_b32 v22, 16, v103
    v_and_b32 v23, 0xffff0000, v103
    v_lshlrev_b32 v24, 16, v104
    v_and_b32 v25, 0xffff0000, v104
    v_lshlrev_b32 v26, 16, v105
    v_and_b32 v27, 0xffff0000, v105
    v_lshlrev_b32 v28, 16, v106
    v_and_b32 v29, 0xffff0000, v106
    v_lshlrev_b32 v30, 16, v107
    v_and_b32 v31, 0xffff0000, v107
    ds_read_b128 v[32:35], v12 offset:0
    ds_read_b64_tr_b16 v[36:37], v13 offset:0
    ds_read_b64_tr_b16 v[38:39], v13 offset:1024
    ds_read_b128 v[40:43], v12 offset:1024
    ds_read_b64_tr_b16 v[44:45], v13 offset:2048
    ds_read_b64_tr_b16 v[46:47], v13 offset:3072
    ds_read_b128 v[48:51], v12 offset:2048
    ds_read_b64_tr_b16 v[52:53], v13 offset:4096
    ds_read_b64_tr_b16 v[54:55], v13 offset:5120
    ds_read_b128 v[56:59], v12 offset:3072
    ds_read_b64_tr_b16 v[60:61], v13 offset:6144
    ds_read_b64_tr_b16 v[62:63], v13 offset:7168
    v_add_u32 v12, 8192, v12
    v_add_u32 v13, 8192, v13
    s_mov_b32 s34, 3
Lcl_35:
    s_waitcnt lgkmcnt(0)
    s_barrier
    v_mfma_f32_32x32x16_bf16 v[16:31], v[36:39], v[32:35], v[16:31]
    ds_read_b128 v[64:67], v12 offset:0
    ds_read_b64_tr_b16 v[68:69], v13 offset:0
    ds_read_b64_tr_b16 v[70:71], v13 offset:1024
    ds_read_b128 v[72:75], v12 offset:1024
    v_mfma_f32_32x32x16_bf16 v[16:31], v[44:47], v[40:43], v[16:31]
    ds_read_b64_tr_b16 v[76:77], v13 offset:2048
    ds_read_b64_tr_b16 v[78:79], v13 offset:3072
    ds_read_b128 v[80:83], v12 offset:2048
    ds_read_b64_tr_b16 v[84:85], v13 offset:4096
    v_mfma_f32_32x32x16_bf16 v[16:31], v[52:55], v[48:51], v[16:31]
    ds_read_b64_tr_b16 v[86:87], v13 offset:5120
    ds_read_b128 v[88:91], v12 offset:3072
    ds_read_b64_tr_b16 v[92:93], v13 offset:6144
    ds_read_b64_tr_b16 v[94:95], v13 offset:7168
    v_mfma_f32_32x32x16_bf16 v[16:31], v[60:63], v[56:59], v[16:31]
    v_add_u32 v12, 8192, v12
    v_add_u32 v13, 8192, v13
    s_sub_u32 s34, s34, 1
    s_waitcnt lgkmcnt(0)
    s_barrier
    v_mfma_f32_32x32x16_bf16 v[16:31], v[68:71], v[64:67], v[16:31]
    ds_read_b128 v[32:35], v12 offset:0
    ds_read_b64_tr_b16 v[36:37], v13 offset:0
    ds_read_b64_tr_b16 v[38:39], v13 offset:1024
    ds_read_b128 v[40:43], v12 offset:1024
    v_mfma_f32_32x32x16_bf16 v[16:31], v[76:79], v[72:75], v[16:31]
    ds_read_b64_tr_b16 v[44:45], v13 offset:2048
    ds_read_b64_tr_b16 v[46:47], v13 offset:3072
    ds_read_b128 v[48:51], v12 offset:2048
    ds_read_b64_tr_b16 v[52:53], v13 offset:4096
    v_mfma_f32_32x32x16_bf16 v[16:31], v[84:87], v[80:83], v[16:31]
    ds_read_b64_tr_b16 v[54:55], v13 offset:5120
    ds_read_b128 v[56:59], v12 offset:3072
    ds_read_b64_tr_b16 v[60:61], v13 offset:6144
    ds_read_b64_tr_b16 v[62:63], v13 offset:7168
    v_mfma_f32_32x32x16_bf16 v[16:31], v[92:95], v[88:91], v[16:31]
    v_add_u32 v12, 8192, v12
    v_add_u32 v13, 8192, v13
    s_cmp_lg_u32 s34, 0
    s_cbranch_scc1 Lcl_35
    s_waitcnt lgkmcnt(9)
    v_mfma_f32_32x32x16_bf16 v[16:31], v[36:39], v[32:35], v[16:31]
    s_waitcnt lgkmcnt(6)
    v_mfma_f32_32x32x16_bf16 v[16:31], v[44:47], v[40:43], v[16:31]
    s_waitcnt lgkmcnt(3)
    v_mfma_f32_32x32x16_bf16 v[16:31], v[52:55], v[48:51], v[16:31]
    s_waitcnt lgkmcnt(0)
    v_mfma_f32_32x32x16_bf16 v[16:31], v[60:63], v[56:59], v[16:31]
    s_barrier
    ds_read_b128 v[64:67], v12 offset:0
    ds_read_b64_tr_b16 v[68:69], v13 offset:0
    ds_read_b64_tr_b16 v[70:71], v13 offset:1024
    ds_read_b128 v[72:75], v12 offset:1024
    ds_read_b64_tr_b16 v[76:77], v13 offset:2048
    ds_read_b64_tr_b16 v[78:79], v13 offset:3072
    ds_read_b128 v[80:83], v12 offset:2048
    ds_read_b64_tr_b16 v[84:85], v13 offset:4096
    ds_read_b64_tr_b16 v[86:87], v13 offset:5120
    ds_read_b128 v[88:91], v12 offset:3072
    ds_read_b64_tr_b16 v[92:93], v13 offset:6144
    ds_read_b64_tr_b16 v[94:95], v13 offset:7168
    s_waitcnt lgkmcnt(9)
    v_mfma_f32_32x32x16_bf16 v[16:31], v[68:71], v[64:67], v[16:31]
    s_waitcnt lgkmcnt(6)
    v_mfma_f32_32x32x16_bf16 v[16:31], v[76:79], v[72:75], v[16:31]
    s_waitcnt lgkmcnt(3)
    v_mfma_f32_32x32x16_bf16 v[16:31], v[84:87], v[80:83], v[16:31]
    s_waitcnt lgkmcnt(0)
    s_barrier
    v_mfma_f32_32x32x16_bf16 v[16:31], v[92:95], v[88:91], v[16:31]
    v_mov_b32 v108, 0x3f803f80
    v_mov_b32 v110, 0
    v_mov_b32 v111, 0
    s_lshl_b32 s38, s36, 15
    s_lshl_b32 s39, s37, 10
    s_add_u32 s38, s38, s39
    s_add_u32 s38, s38, 8388608
    s_lshl_b32 s39, s36, 12
    s_lshl_b32 s40, s37, 7
    s_add_u32 s39, s39, s40
    s_add_u32 s39, s39, 10485760
    v_lshlrev_b32 v109, 3, v3
    s_nop 2
    v_cvt_pk_bf16_f32 v160, v16, v17
    v_cvt_pk_bf16_f32 v161, v18, v19
    v_cvt_pk_bf16_f32 v162, v20, v21
    v_cvt_pk_bf16_f32 v163, v22, v23
    v_cvt_pk_bf16_f32 v164, v24, v25
    v_cvt_pk_bf16_f32 v165, v26, v27
    v_cvt_pk_bf16_f32 v166, v28, v29
    v_cvt_pk_bf16_f32 v167, v30, v31
    buffer_store_dwordx4 v[160:163], v2, s[12:15], s38 offen sc1
    buffer_store_dwordx4 v[164:167], v2, s[12:15], s38 offen offset:1024 sc1
    v_dot2_f32_bf16 v110, v160, v108, v110
    v_dot2_f32_bf16 v111, v160, v160, v111
    v_dot2_f32_bf16 v110, v161, v108, v110
    v_dot2_f32_bf16 v111, v161, v161, v111
    v_dot2_f32_bf16 v110, v162, v108, v110
    v_dot2_f32_bf16 v111, v162, v162, v111
    v_dot2_f32_bf16 v110, v163, v108, v110
    v_dot2_f32_bf16 v111, v163, v163, v111
    v_dot2_f32_bf16 v110, v164, v108, v110
    v_dot2_f32_bf16 v111, v164, v164, v111
    v_dot2_f32_bf16 v110, v165, v108, v110
    v_dot2_f32_bf16 v111, v165, v165, v111
    v_dot2_f32_bf16 v110, v166, v108, v110
    v_dot2_f32_bf16 v111, v166, v166, v111
    v_dot2_f32_bf16 v110, v167, v108, v110
    v_dot2_f32_bf16 v111, v167, v167, v111
    s_nop 2
    v_mov_b32 v112, v110
    s_nop 1
    v_permlane32_swap_b32 v110, v112
    s_nop 1
    v_add_f32 v110, v110, v112
    v_mov_b32 v112, v111
    s_nop 1
    v_permlane32_swap_b32 v111, v112
    s_nop 1
    v_add_f32 v111, v111, v112
    s_mov_b32 exec_hi, 0
    buffer_store_dwordx2 v[110:111], v109, s[12:15], s39 offen sc1
    s_mov_b64 exec, -1
    s_branch LendC_33
LhiC_32:
    s_mov_b32 s34, 9
Lidle_36:
    s_barrier
    s_sub_u32 s34, s34, 1
    s_cmp_lg_u32 s34, 0
    s_cbranch_scc1 Lidle_36
LendC_33:
    s_cmp_lt_u32 s2, 224
    s_cbranch_scc1 LphD_37
    s_cmp_lg_u32 s28, 7
    s_cbranch_scc1 Lna_39
    s_lshl_b32 s46, s22, 3
    s_add_u32 s46, s46, s23
    s_lshr_b32 s47, s22, 1
    s_lshl_b32 s47, s47, 4
    s_lshl_b32 s44, s47, 7
    s_add_u32 s44, s44, 11632640
    v_lshlrev_b32 v6, 7, v0
    s_mov_b32 s48, 0x3fff
    s_mov_b32 s49, 0
    s_lshl_b32 s46, s46, 7
    s_add_u32 s46, s46, 11599872
    v_mov_b32 v4, s84
    v_mov_b32 v5, s85
    v_mov_b32 v7, 0
Lna_39:
    s_waitcnt vmcnt(0)
    s_cmp_lg_u32 s28, 7
    s_barrier
    s_cbranch_scc1 Lns_40
    s_mov_b64 exec, 1
    buffer_store_dwordx2 v[4:5], v7, s[12:15], s46 offen sc1
    s_mov_b64 exec, -1
Lns_40:
    s_barrier
    s_cmp_ge_u32 s28, 4
    s_cbranch_scc1 Lebh_42
    s_and_b32 s29, s28, 1
    s_bfe_u32 s30, s28, 0x10001
    s_lshl_b32 s31, s30, 6
    s_lshl_b32 s32, s29, 12
    v_add_u32 v10, s32, v2
    s_lshl_b32 s36, s22, 1
    s_add_u32 s36, s36, s29
    s_lshl_b32 s37, s23, 2
    s_lshl_b32 s38, s30, 1
    s_add_u32 s37, s37, s38
    v_mul_u32_u24 v11, 512, v1
    v_bfe_u32 v14, v0, 2, 2
    v_lshl_add_u32 v11, v14, 7, v11
    v_bfe_u32 v14, v0, 4, 1
    v_lshlrev_b32 v14, 5, v14
    v_and_b32 v15, 3, v0
    v_lshl_add_u32 v14, v15, 3, v14
    v_add_u32 v14, s31, v14
    v_bfe_u32 v15, v0, 3, 1
    v_lshlrev_b32 v15, 6, v15
    v_xor_b32 v14, v14, v15
    v_add_u32 v11, v11, v14
    v_add_u32 v10, 98304, v10
    s_mov_b32 s33, 0
    v_mov_b32 v12, v10
    v_mov_b32 v13, v11
    s_mov_b32 s35, 0
    s_lshl_b32 s38, s28, 12
    s_add_u32 s38, s38, 32768
    v_add_u32 v14, s38, v2
    s_lshl_b32 s38, s36, 15
    s_lshl_b32 s39, s37, 5
    s_add_u32 s38, s38, s39
    v_lshlrev_b32 v15, 10, v3
    v_lshl_add_u32 v15, v1, 4, v15
    s_mov_b32 s16, s78
    s_mov_b32 s17, s79
    s_mov_b32 s18, 2097152
    s_mov_b32 s19, 0x00020000
    v_lshlrev_b32 v136, 16, v160
    v_and_b32 v137, 0xffff0000, v160
    v_lshlrev_b32 v138, 16, v161
    v_and_b32 v139, 0xffff0000, v161
    v_lshlrev_b32 v140, 16, v162
    v_and_b32 v141, 0xffff0000, v162
    v_lshlrev_b32 v142, 16, v163
    v_and_b32 v143, 0xffff0000, v163
    v_lshlrev_b32 v144, 16, v164
    v_and_b32 v145, 0xffff0000, v164
    v_lshlrev_b32 v146, 16, v165
    v_and_b32 v147, 0xffff0000, v165
    v_lshlrev_b32 v148, 16, v166
    v_and_b32 v149, 0xffff0000, v166
    v_lshlrev_b32 v150, 16, v167
    v_and_b32 v151, 0xffff0000, v167
    v_mov_b32 v16, 0
    v_mov_b32 v17, 0
    v_mov_b32 v18, 0
    v_mov_b32 v19, 0
    v_mov_b32 v20, 0
    v_mov_b32 v21, 0
    v_mov_b32 v22, 0
    v_mov_b32 v23, 0
    v_mov_b32 v24, 0
    v_mov_b32 v25, 0
    v_mov_b32 v26, 0
    v_mov_b32 v27, 0
    v_mov_b32 v28, 0
    v_mov_b32 v29, 0
    v_mov_b32 v30, 0
    v_mov_b32 v31, 0
    v_mov_b32 v152, 0x3f317218
    s_branch Lebj_43
Lebh_42:
    s_sub_u32 s29, s28, 4
    s_lshl_b32 s33, s29, 10
    s_lshl_b32 s35, s29, 11
    s_lshl_b32 s29, s29, 4
    s_lshl_b32 s30, s23, 7
    s_mov_b32 s40, 1572864
    s_mul_i32 s41, s22, 229376
    s_add_u32 s41, s41, s33
    s_add_u32 s41, s41, 12582912
    v_lshrrev_b32 v15, 3, v0
    v_add_u32 v15, s29, v15
    v_mul_u32_u24 v14, 1024, v15
    v_and_b32 v15, 7, v0
    v_bfe_u32 v16, v0, 4, 1
    v_lshlrev_b32 v16, 2, v16
    v_xor_b32 v15, v15, v16
    v_lshl_add_u32 v14, v15, 4, v14
    v_add_u32 v14, s30, v14
    s_mov_b32 s16, s76
    s_mov_b32 s17, s77
    s_mov_b32 s18, 1835008
    s_mov_b32 s19, 0x00020000
    s_setprio 3
Lebj_43:
    s_barrier
    s_cmp_lg_u32 s28, 7
    s_cbranch_scc1 Lnp_41
    s_mov_b64 exec, s[48:49]
    buffer_load_dwordx2 v[8:9], v6, s[12:15], s44 offen sc1
    s_mov_b64 exec, -1
    s_mov_b32 s45, 30000
    s_mov_b64 exec, s[48:49]
Lpoll_44:
    s_waitcnt vmcnt(0)
    v_cmp_ne_u64 vcc, s[84:85], v[8:9]
    s_cbranch_vccz Lpolld_45
    s_mov_b64 exec, vcc
    buffer_load_dwordx2 v[8:9], v6, s[12:15], s44 offen sc1
    s_sub_u32 s45, s45, 1
    s_cmp_lg_u32 s45, 0
    s_cbranch_scc1 Lpoll_44
Lpolld_45:
    s_mov_b64 exec, -1
Lnp_41:
    s_barrier
    s_branch LphE_38
LphD_37:
    s_cmp_lg_u32 s28, 7
    s_cbranch_scc1 Lna_46
    s_lshl_b32 s46, s22, 3
    s_add_u32 s46, s46, s23
    s_lshl_b32 s47, s26, 4
    s_lshl_b32 s44, s47, 7
    s_add_u32 s44, s44, 11599872
    v_lshlrev_b32 v6, 7, v0
    s_mov_b32 s48, 0xffff
    s_mov_b32 s49, 0
    s_lshl_b32 s46, s46, 7
    s_add_u32 s46, s46, 11599872
    v_mov_b32 v4, s84
    v_mov_b32 v5, s85
    v_mov_b32 v7, 0
Lna_46:
    s_waitcnt vmcnt(0)
    s_cmp_lg_u32 s28, 7
    s_barrier
    s_cbranch_scc1 Lns_47
    s_mov_b64 exec, 1
    buffer_store_dwordx2 v[4:5], v7, s[12:15], s46 offen sc1
    s_mov_b64 exec, -1
Lns_47:
    s_barrier
    s_and_b32 s29, s28, 1
    s_lshr_b32 s30, s28, 1
    s_and_b32 s31, s30, 1
    s_lshl_b32 s31, s31, 6
    s_lshr_b32 s32, s30, 1
    s_lshl_b32 s32, s32, 13
    s_lshl_b32 s33, s29, 13
    s_add_u32 s33, s33, 81920
    v_add_u32 v10, s33, v2
    s_lshl_b32 s36, s26, 2
    s_lshl_b32 s37, s29, 1
    s_add_u32 s36, s36, s37
    s_lshl_b32 s37, s27, 2
    s_add_u32 s37, s37, s30
    s_lshl_b32 s38, s30, 10
    s_add_u32 s38, s38, 147456
    v_add_u32 v136, s38, v2
    s_lshl_b32 s38, s29, 11
    s_add_u32 s38, s38, 151552
    v_add_u32 v137, s38, v2
    s_mul_i32 s38, s36, 114688
    s_lshl_b32 s39, s37, 11
    s_add_u32 s38, s38, s39
    s_add_u32 s38, s38, 12582912
    s_add_u32 s39, s38, 114688
    v_mov_b32 v138, 0xbfb17218
    v_mul_u32_u24 v11, 512, v1
    v_bfe_u32 v144, v0, 2, 2
    v_lshl_add_u32 v11, v144, 7, v11
    v_bfe_u32 v144, v0, 4, 1
    v_lshlrev_b32 v144, 5, v144
    v_and_b32 v145, 3, v0
    v_lshl_add_u32 v144, v145, 3, v144
    v_add_u32 v144, s31, v144
    v_bfe_u32 v145, v0, 3, 1
    v_lshlrev_b32 v145, 6, v145
    v_xor_b32 v144, v144, v145
    v_add_u32 v11, v11, v144
    v_add_u32 v11, s32, v11
    v_mov_b32 v12, v10
    v_mov_b32 v13, v11
    s_mov_b32 s33, 0
    s_mov_b32 s35, 0
    v_mov_b32 v16, 0
    v_mov_b32 v17, 0
    v_mov_b32 v18, 0
    v_mov_b32 v19, 0
    v_mov_b32 v20, 0
    v_mov_b32 v21, 0
    v_mov_b32 v22, 0
    v_mov_b32 v23, 0
    v_mov_b32 v24, 0
    v_mov_b32 v25, 0
    v_mov_b32 v26, 0
    v_mov_b32 v27, 0
    v_mov_b32 v28, 0
    v_mov_b32 v29, 0
    v_mov_b32 v30, 0
    v_mov_b32 v31, 0
    v_mov_b32 v32, 0
    v_mov_b32 v33, 0
    v_mov_b32 v34, 0
    v_mov_b32 v35, 0
    v_mov_b32 v36, 0
    v_mov_b32 v37, 0
    v_mov_b32 v38, 0
    v_mov_b32 v39, 0
    v_mov_b32 v40, 0
    v_mov_b32 v41, 0
    v_mov_b32 v42, 0
    v_mov_b32 v43, 0
    v_mov_b32 v44, 0
    v_mov_b32 v45, 0
    v_mov_b32 v46, 0
    v_mov_b32 v47, 0
    s_cmp_ge_u32 s28, 4
    s_cbranch_scc1 Ldp_49
    s_setprio 1
Ldp_49:
    s_barrier
    s_cmp_lg_u32 s28, 7
    s_cbranch_scc1 Lnp_48
    s_mov_b64 exec, s[48:49]
    buffer_load_dwordx2 v[8:9], v6, s[12:15], s44 offen sc1
    s_mov_b64 exec, -1
    s_mov_b32 s45, 30000
    s_mov_b64 exec, s[48:49]
Lpoll_50:
    s_waitcnt vmcnt(0)
    v_cmp_ne_u64 vcc, s[84:85], v[8:9]
    s_cbranch_vccz Lpolld_51
    s_mov_b64 exec, vcc
    buffer_load_dwordx2 v[8:9], v6, s[12:15], s44 offen sc1
    s_sub_u32 s45, s45, 1
    s_cmp_lg_u32 s45, 0
    s_cbranch_scc1 Lpoll_50
Lpolld_51:
    s_mov_b64 exec, -1
Lnp_48:
    s_barrier
    s_barrier
    ds_read_b64_tr_b16 v[56:57], v13 offset:0
    ds_read_b64_tr_b16 v[58:59], v13 offset:1024
    ds_read_b128 v[48:51], v12 offset:0
    ds_read_b128 v[52:55], v12 offset:4096
    ds_read_b64_tr_b16 v[68:69], v13 offset:2048
    ds_read_b64_tr_b16 v[70:71], v13 offset:3072
    ds_read_b128 v[60:63], v12 offset:1024
    ds_read_b128 v[64:67], v12 offset:5120
    s_mov_b32 s34, 7
Lcl_52:
    s_waitcnt lgkmcnt(0)
    v_mfma_f32_32x32x16_bf16 v[16:31], v[56:59], v[48:51], v[16:31]
    ds_read_b64_tr_b16 v[80:81], v13 offset:4096
    ds_read_b64_tr_b16 v[82:83], v13 offset:5120
    ds_read_b128 v[72:75], v12 offset:2048
    v_mfma_f32_32x32x16_bf16 v[32:47], v[56:59], v[52:55], v[32:47]
    ds_read_b128 v[76:79], v12 offset:6144
    ds_read_b64_tr_b16 v[92:93], v13 offset:6144
    ds_read_b64_tr_b16 v[94:95], v13 offset:7168
    v_mfma_f32_32x32x16_bf16 v[16:31], v[68:71], v[60:63], v[16:31]
    ds_read_b128 v[84:87], v12 offset:3072
    ds_read_b128 v[88:91], v12 offset:7168
    v_mfma_f32_32x32x16_bf16 v[32:47], v[68:71], v[64:67], v[32:47]
    s_add_u32 s33, s33, 16384
    s_cmp_eq_u32 s33, 65536
    s_cselect_b32 s33, 0, s33
    s_add_u32 s35, s35, 16384
    s_cmp_eq_u32 s35, 81920
    s_cselect_b32 s35, 0, s35
    v_add_u32 v12, s33, v10
    v_add_u32 v13, s35, v11
    s_sub_u32 s34, s34, 1
    s_waitcnt lgkmcnt(0)
    s_barrier
    v_mfma_f32_32x32x16_bf16 v[16:31], v[80:83], v[72:75], v[16:31]
    ds_read_b64_tr_b16 v[56:57], v13 offset:0
    ds_read_b64_tr_b16 v[58:59], v13 offset:1024
    ds_read_b128 v[48:51], v12 offset:0
    v_mfma_f32_32x32x16_bf16 v[32:47], v[80:83], v[76:79], v[32:47]
    ds_read_b128 v[52:55], v12 offset:4096
    ds_read_b64_tr_b16 v[68:69], v13 offset:2048
    ds_read_b64_tr_b16 v[70:71], v13 offset:3072
    v_mfma_f32_32x32x16_bf16 v[16:31], v[92:95], v[84:87], v[16:31]
    ds_read_b128 v[60:63], v12 offset:1024
    ds_read_b128 v[64:67], v12 offset:5120
    v_mfma_f32_32x32x16_bf16 v[32:47], v[92:95], v[88:91], v[32:47]
    s_cmp_lg_u32 s34, 0
    s_cbranch_scc1 Lcl_52
    ds_read_b128 v[96:99], v136
    ds_read_b128 v[100:103], v137
    ds_read_b128 v[104:107], v137 offset:1024
    s_waitcnt lgkmcnt(0)
    v_mov_b32 v8, v103
    v_mov_b32 v9, v107
    v_mov_b32 v103, 0
    v_mov_b32 v107, 0
    s_nop 0
    v_mfma_f32_32x32x16_bf16 v[16:31], v[96:99], v[100:103], v[16:31]
    v_mfma_f32_32x32x16_bf16 v[32:47], v[96:99], v[104:107], v[32:47]
    v_mfma_f32_32x32x16_bf16 v[16:31], v[56:59], v[48:51], v[16:31]
    ds_read_b64_tr_b16 v[80:81], v13 offset:4096
    ds_read_b64_tr_b16 v[82:83], v13 offset:5120
    ds_read_b128 v[72:75], v12 offset:2048
    v_mfma_f32_32x32x16_bf16 v[32:47], v[56:59], v[52:55], v[32:47]
    ds_read_b128 v[76:79], v12 offset:6144
    ds_read_b64_tr_b16 v[92:93], v13 offset:6144
    ds_read_b64_tr_b16 v[94:95], v13 offset:7168
    v_mfma_f32_32x32x16_bf16 v[16:31], v[68:71], v[60:63], v[16:31]
    ds_read_b128 v[84:87], v12 offset:3072
    ds_read_b128 v[88:91], v12 offset:7168
    v_mfma_f32_32x32x16_bf16 v[32:47], v[68:71], v[64:67], v[32:47]
    s_waitcnt lgkmcnt(4)
    v_mfma_f32_32x32x16_bf16 v[16:31], v[80:83], v[72:75], v[16:31]
    v_mfma_f32_32x32x16_bf16 v[32:47], v[80:83], v[76:79], v[32:47]
    s_waitcnt lgkmcnt(0)
    s_barrier
    v_mfma_f32_32x32x16_bf16 v[16:31], v[92:95], v[84:87], v[16:31]
    v_mfma_f32_32x32x16_bf16 v[32:47], v[92:95], v[88:91], v[32:47]
    s_nop 11
    v_mul_f32 v16, v16, v8
    v_mul_f32 v17, v17, v8
    v_mul_f32 v18, v18, v8
    v_mul_f32 v19, v19, v8
    v_mul_f32 v20, v20, v8
    v_mul_f32 v21, v21, v8
    v_mul_f32 v22, v22, v8
    v_mul_f32 v23, v23, v8
    v_mul_f32 v24, v24, v8
    v_mul_f32 v25, v25, v8
    v_mul_f32 v26, v26, v8
    v_mul_f32 v27, v27, v8
    v_mul_f32 v28, v28, v8
    v_mul_f32 v29, v29, v8
    v_mul_f32 v30, v30, v8
    v_mul_f32 v31, v31, v8
    v_exp_f32 v48, v16
    v_exp_f32 v49, v17
    v_exp_f32 v50, v18
    v_exp_f32 v51, v19
    v_exp_f32 v52, v20
    v_exp_f32 v53, v21
    v_exp_f32 v54, v22
    v_exp_f32 v55, v23
    v_exp_f32 v56, v24
    v_exp_f32 v57, v25
    v_exp_f32 v58, v26
    v_exp_f32 v59, v27
    v_exp_f32 v60, v28
    v_exp_f32 v61, v29
    v_exp_f32 v62, v30
    v_exp_f32 v63, v31
    v_fma_f32 v80, v48, -0.5, -1.0
    v_fma_f32 v81, v49, -0.5, -1.0
    v_fma_f32 v82, v50, -0.5, -1.0
    v_fma_f32 v83, v51, -0.5, -1.0
    v_fma_f32 v84, v52, -0.5, -1.0
    v_fma_f32 v85, v53, -0.5, -1.0
    v_fma_f32 v86, v54, -0.5, -1.0
    v_fma_f32 v87, v55, -0.5, -1.0
    v_fma_f32 v88, v56, -0.5, -1.0
    v_fma_f32 v89, v57, -0.5, -1.0
    v_fma_f32 v90, v58, -0.5, -1.0
    v_fma_f32 v91, v59, -0.5, -1.0
    v_fma_f32 v92, v60, -0.5, -1.0
    v_fma_f32 v93, v61, -0.5, -1.0
    v_fma_f32 v94, v62, -0.5, -1.0
    v_fma_f32 v95, v63, -0.5, -1.0
    v_fma_f32 v48, v48, v80, -1.0
    v_fma_f32 v49, v49, v81, -1.0
    v_fma_f32 v50, v50, v82, -1.0
    v_fma_f32 v51, v51, v83, -1.0
    v_fma_f32 v52, v52, v84, -1.0
    v_fma_f32 v53, v53, v85, -1.0
    v_fma_f32 v54, v54, v86, -1.0
    v_fma_f32 v55, v55, v87, -1.0
    v_fma_f32 v56, v56, v88, -1.0
    v_fma_f32 v57, v57, v89, -1.0
    v_fma_f32 v58, v58, v90, -1.0
    v_fma_f32 v59, v59, v91, -1.0
    v_fma_f32 v60, v60, v92, -1.0
    v_fma_f32 v61, v61, v93, -1.0
    v_fma_f32 v62, v62, v94, -1.0
    v_fma_f32 v63, v63, v95, -1.0
    v_rcp_f32 v48, v48
    v_rcp_f32 v49, v49
    v_rcp_f32 v50, v50
    v_rcp_f32 v51, v51
    v_rcp_f32 v52, v52
    v_rcp_f32 v53, v53
    v_rcp_f32 v54, v54
    v_rcp_f32 v55, v55
    v_rcp_f32 v56, v56
    v_rcp_f32 v57, v57
    v_rcp_f32 v58, v58
    v_rcp_f32 v59, v59
    v_rcp_f32 v60, v60
    v_rcp_f32 v61, v61
    v_rcp_f32 v62, v62
    v_rcp_f32 v63, v63
    v_fmac_f32 v16, v16, v48
    v_fmac_f32 v17, v17, v49
    v_fmac_f32 v18, v18, v50
    v_fmac_f32 v19, v19, v51
    v_fmac_f32 v20, v20, v52
    v_fmac_f32 v21, v21, v53
    v_fmac_f32 v22, v22, v54
    v_fmac_f32 v23, v23, v55
    v_fmac_f32 v24, v24, v56
    v_fmac_f32 v25, v25, v57
    v_fmac_f32 v26, v26, v58
    v_fmac_f32 v27, v27, v59
    v_fmac_f32 v28, v28, v60
    v_fmac_f32 v29, v29, v61
    v_fmac_f32 v30, v30, v62
    v_fmac_f32 v31, v31, v63
    v_cvt_pk_bf16_f32 v64, v16, v17
    v_cvt_pk_bf16_f32 v65, v18, v19
    v_cvt_pk_bf16_f32 v66, v20, v21
    v_cvt_pk_bf16_f32 v67, v22, v23
    v_cvt_pk_bf16_f32 v68, v24, v25
    v_cvt_pk_bf16_f32 v69, v26, v27
    v_cvt_pk_bf16_f32 v70, v28, v29
    v_cvt_pk_bf16_f32 v71, v30, v31
    buffer_store_dwordx4 v[64:67], v2, s[12:15], s38 offen sc1
    buffer_store_dwordx4 v[68:71], v2, s[12:15], s38 offen offset:1024 sc1
    v_mul_f32 v32, v32, v9
    v_mul_f32 v33, v33, v9
    v_mul_f32 v34, v34, v9
    v_mul_f32 v35, v35, v9
    v_mul_f32 v36, v36, v9
    v_mul_f32 v37, v37, v9
    v_mul_f32 v38, v38, v9
    v_mul_f32 v39, v39, v9
    v_mul_f32 v40, v40, v9
    v_mul_f32 v41, v41, v9
    v_mul_f32 v42, v42, v9
    v_mul_f32 v43, v43, v9
    v_mul_f32 v44, v44, v9
    v_mul_f32 v45, v45, v9
    v_mul_f32 v46, v46, v9
    v_mul_f32 v47, v47, v9
    v_exp_f32 v48, v32
    v_exp_f32 v49, v33
    v_exp_f32 v50, v34
    v_exp_f32 v51, v35
    v_exp_f32 v52, v36
    v_exp_f32 v53, v37
    v_exp_f32 v54, v38
    v_exp_f32 v55, v39
    v_exp_f32 v56, v40
    v_exp_f32 v57, v41
    v_exp_f32 v58, v42
    v_exp_f32 v59, v43
    v_exp_f32 v60, v44
    v_exp_f32 v61, v45
    v_exp_f32 v62, v46
    v_exp_f32 v63, v47
    v_fma_f32 v80, v48, -0.5, -1.0
    v_fma_f32 v81, v49, -0.5, -1.0
    v_fma_f32 v82, v50, -0.5, -1.0
    v_fma_f32 v83, v51, -0.5, -1.0
    v_fma_f32 v84, v52, -0.5, -1.0
    v_fma_f32 v85, v53, -0.5, -1.0
    v_fma_f32 v86, v54, -0.5, -1.0
    v_fma_f32 v87, v55, -0.5, -1.0
    v_fma_f32 v88, v56, -0.5, -1.0
    v_fma_f32 v89, v57, -0.5, -1.0
    v_fma_f32 v90, v58, -0.5, -1.0
    v_fma_f32 v91, v59, -0.5, -1.0
    v_fma_f32 v92, v60, -0.5, -1.0
    v_fma_f32 v93, v61, -0.5, -1.0
    v_fma_f32 v94, v62, -0.5, -1.0
    v_fma_f32 v95, v63, -0.5, -1.0
    v_fma_f32 v48, v48, v80, -1.0
    v_fma_f32 v49, v49, v81, -1.0
    v_fma_f32 v50, v50, v82, -1.0
    v_fma_f32 v51, v51, v83, -1.0
    v_fma_f32 v52, v52, v84, -1.0
    v_fma_f32 v53, v53, v85, -1.0
    v_fma_f32 v54, v54, v86, -1.0
    v_fma_f32 v55, v55, v87, -1.0
    v_fma_f32 v56, v56, v88, -1.0
    v_fma_f32 v57, v57, v89, -1.0
    v_fma_f32 v58, v58, v90, -1.0
    v_fma_f32 v59, v59, v91, -1.0
    v_fma_f32 v60, v60, v92, -1.0
    v_fma_f32 v61, v61, v93, -1.0
    v_fma_f32 v62, v62, v94, -1.0
    v_fma_f32 v63, v63, v95, -1.0
    v_rcp_f32 v48, v48
    v_rcp_f32 v49, v49
    v_rcp_f32 v50, v50
    v_rcp_f32 v51, v51
    v_rcp_f32 v52, v52
    v_rcp_f32 v53, v53
    v_rcp_f32 v54, v54
    v_rcp_f32 v55, v55
    v_rcp_f32 v56, v56
    v_rcp_f32 v57, v57
    v_rcp_f32 v58, v58
    v_rcp_f32 v59, v59
    v_rcp_f32 v60, v60
    v_rcp_f32 v61, v61
    v_rcp_f32 v62, v62
    v_rcp_f32 v63, v63
    v_fmac_f32 v32, v32, v48
    v_fmac_f32 v33, v33, v49
    v_fmac_f32 v34, v34, v50
    v_fmac_f32 v35, v35, v51
    v_fmac_f32 v36, v36, v52
    v_fmac_f32 v37, v37, v53
    v_fmac_f32 v38, v38, v54
    v_fmac_f32 v39, v39, v55
    v_fmac_f32 v40, v40, v56
    v_fmac_f32 v41, v41, v57
    v_fmac_f32 v42, v42, v58
    v_fmac_f32 v43, v43, v59
    v_fmac_f32 v44, v44, v60
    v_fmac_f32 v45, v45, v61
    v_fmac_f32 v46, v46, v62
    v_fmac_f32 v47, v47, v63
    v_cvt_pk_bf16_f32 v72, v32, v33
    v_cvt_pk_bf16_f32 v73, v34, v35
    v_cvt_pk_bf16_f32 v74, v36, v37
    v_cvt_pk_bf16_f32 v75, v38, v39
    v_cvt_pk_bf16_f32 v76, v40, v41
    v_cvt_pk_bf16_f32 v77, v42, v43
    v_cvt_pk_bf16_f32 v78, v44, v45
    v_cvt_pk_bf16_f32 v79, v46, v47
    buffer_store_dwordx4 v[72:75], v2, s[12:15], s39 offen sc1
    buffer_store_dwordx4 v[76:79], v2, s[12:15], s39 offen offset:1024 sc1
    s_setprio 0
    s_cmp_lg_u32 s28, 7
    s_cbranch_scc1 Lna_53
    s_lshl_b32 s46, s26, 4
    s_add_u32 s46, s46, s27
    s_lshr_b32 s47, s22, 1
    s_lshl_b32 s47, s47, 4
    s_lshl_b32 s44, s47, 7
    s_add_u32 s44, s44, 11632640
    v_lshlrev_b32 v6, 7, v0
    s_mov_b32 s48, 0x3fff
    s_mov_b32 s49, 0
    s_lshl_b32 s46, s46, 7
    s_add_u32 s46, s46, 11632640
    v_mov_b32 v4, s84
    v_mov_b32 v5, s85
    v_mov_b32 v7, 0
Lna_53:
    s_waitcnt vmcnt(0)
    s_cmp_lg_u32 s28, 7
    s_barrier
    s_cbranch_scc1 Lns_54
    s_mov_b64 exec, 1
    buffer_store_dwordx2 v[4:5], v7, s[12:15], s46 offen sc1
    s_mov_b64 exec, -1
Lns_54:
    s_barrier
    s_cmp_ge_u32 s28, 4
    s_cbranch_scc1 Lebh_56
    s_and_b32 s29, s28, 1
    s_bfe_u32 s30, s28, 0x10001
    s_lshl_b32 s31, s30, 6
    s_lshl_b32 s32, s29, 12
    v_add_u32 v10, s32, v2
    s_lshl_b32 s36, s22, 1
    s_add_u32 s36, s36, s29
    s_lshl_b32 s37, s23, 2
    s_lshl_b32 s38, s30, 1
    s_add_u32 s37, s37, s38
    v_mul_u32_u24 v11, 512, v1
    v_bfe_u32 v14, v0, 2, 2
    v_lshl_add_u32 v11, v14, 7, v11
    v_bfe_u32 v14, v0, 4, 1
    v_lshlrev_b32 v14, 5, v14
    v_and_b32 v15, 3, v0
    v_lshl_add_u32 v14, v15, 3, v14
    v_add_u32 v14, s31, v14
    v_bfe_u32 v15, v0, 3, 1
    v_lshlrev_b32 v15, 6, v15
    v_xor_b32 v14, v14, v15
    v_add_u32 v11, v11, v14
    v_add_u32 v10, 98304, v10
    s_mov_b32 s33, 0
    v_mov_b32 v12, v10
    v_mov_b32 v13, v11
    s_mov_b32 s35, 0
    s_lshl_b32 s38, s28, 12
    s_add_u32 s38, s38, 32768
    v_add_u32 v14, s38, v2
    s_lshl_b32 s38, s36, 15
    s_lshl_b32 s39, s37, 5
    s_add_u32 s38, s38, s39
    v_lshlrev_b32 v15, 10, v3
    v_lshl_add_u32 v15, v1, 4, v15
    s_mov_b32 s16, s78
    s_mov_b32 s17, s79
    s_mov_b32 s18, 2097152
    s_mov_b32 s19, 0x00020000
    v_lshlrev_b32 v136, 16, v160
    v_and_b32 v137, 0xffff0000, v160
    v_lshlrev_b32 v138, 16, v161
    v_and_b32 v139, 0xffff0000, v161
    v_lshlrev_b32 v140, 16, v162
    v_and_b32 v141, 0xffff0000, v162
    v_lshlrev_b32 v142, 16, v163
    v_and_b32 v143, 0xffff0000, v163
    v_lshlrev_b32 v144, 16, v164
    v_and_b32 v145, 0xffff0000, v164
    v_lshlrev_b32 v146, 16, v165
    v_and_b32 v147, 0xffff0000, v165
    v_lshlrev_b32 v148, 16, v166
    v_and_b32 v149, 0xffff0000, v166
    v_lshlrev_b32 v150, 16, v167
    v_and_b32 v151, 0xffff0000, v167
    v_mov_b32 v16, 0
    v_mov_b32 v17, 0
    v_mov_b32 v18, 0
    v_mov_b32 v19, 0
    v_mov_b32 v20, 0
    v_mov_b32 v21, 0
    v_mov_b32 v22, 0
    v_mov_b32 v23, 0
    v_mov_b32 v24, 0
    v_mov_b32 v25, 0
    v_mov_b32 v26, 0
    v_mov_b32 v27, 0
    v_mov_b32 v28, 0
    v_mov_b32 v29, 0
    v_mov_b32 v30, 0
    v_mov_b32 v31, 0
    v_mov_b32 v152, 0x3f317218
    s_branch Lebj_57
Lebh_56:
    s_sub_u32 s29, s28, 4
    s_lshl_b32 s33, s29, 10
    s_lshl_b32 s35, s29, 11
    s_lshl_b32 s29, s29, 4
    s_lshl_b32 s30, s23, 7
    s_mov_b32 s40, 1572864
    s_mul_i32 s41, s22, 229376
    s_add_u32 s41, s41, s33
    s_add_u32 s41, s41, 12582912
    v_lshrrev_b32 v15, 3, v0
    v_add_u32 v15, s29, v15
    v_mul_u32_u24 v14, 1024, v15
    v_and_b32 v15, 7, v0
    v_bfe_u32 v16, v0, 4, 1
    v_lshlrev_b32 v16, 2, v16
    v_xor_b32 v15, v15, v16
    v_lshl_add_u32 v14, v15, 4, v14
    v_add_u32 v14, s30, v14
    s_mov_b32 s16, s76
    s_mov_b32 s17, s77
    s_mov_b32 s18, 1835008
    s_mov_b32 s19, 0x00020000
    s_setprio 3
Lebj_57:
    s_barrier
    s_cmp_lg_u32 s28, 7
    s_cbranch_scc1 Lnp_55
    s_mov_b64 exec, s[48:49]
    buffer_load_dwordx2 v[8:9], v6, s[12:15], s44 offen sc1
    s_mov_b64 exec, -1
    s_mov_b32 s45, 30000
    s_mov_b64 exec, s[48:49]
Lpoll_58:
    s_waitcnt vmcnt(0)
    v_cmp_ne_u64 vcc, s[84:85], v[8:9]
    s_cbranch_vccz Lpolld_59
    s_mov_b64 exec, vcc
    buffer_load_dwordx2 v[8:9], v6, s[12:15], s44 offen sc1
    s_sub_u32 s45, s45, 1
    s_cmp_lg_u32 s45, 0
    s_cbranch_scc1 Lpoll_58
Lpolld_59:
    s_mov_b64 exec, -1
Lnp_55:
    s_barrier
LphE_38:
    s_cmp_ge_u32 s28, 4
    s_cbranch_scc1 LhiE_60
    s_barrier
    ds_read_b128 v[32:35], v12 offset:0
    ds_read_b64_tr_b16 v[36:37], v13 offset:0
    ds_read_b64_tr_b16 v[38:39], v13 offset:1024
    ds_read_b128 v[40:43], v12 offset:1024
    ds_read_b64_tr_b16 v[44:45], v13 offset:2048
    ds_read_b64_tr_b16 v[46:47], v13 offset:3072
    ds_read_b128 v[48:51], v12 offset:2048
    ds_read_b64_tr_b16 v[52:53], v13 offset:4096
    ds_read_b64_tr_b16 v[54:55], v13 offset:5120
    ds_read_b128 v[56:59], v12 offset:3072
    ds_read_b64_tr_b16 v[60:61], v13 offset:6144
    ds_read_b64_tr_b16 v[62:63], v13 offset:7168
    s_add_u32 s33, s33, 16384
    s_cmp_eq_u32 s33, 65536
    s_cselect_b32 s33, 0, s33
    s_add_u32 s35, s35, 8192
    s_cmp_eq_u32 s35, 98304
    s_cselect_b32 s35, 0, s35
    v_add_u32 v12, s33, v10
    v_add_u32 v13, s35, v11
    s_mov_b32 s34, 6
Lgl_61:
    s_waitcnt lgkmcnt(0)
    s_barrier
    v_mfma_f32_32x32x16_bf16 v[16:31], v[36:39], v[32:35], v[16:31]
    ds_read_b128 v[64:67], v12 offset:0
    ds_read_b64_tr_b16 v[68:69], v13 offset:0
    ds_read_b64_tr_b16 v[70:71], v13 offset:1024
    ds_read_b128 v[72:75], v12 offset:1024
    v_mfma_f32_32x32x16_bf16 v[16:31], v[44:47], v[40:43], v[16:31]
    ds_read_b64_tr_b16 v[76:77], v13 offset:2048
    ds_read_b64_tr_b16 v[78:79], v13 offset:3072
    ds_read_b128 v[80:83], v12 offset:2048
    ds_read_b64_tr_b16 v[84:85], v13 offset:4096
    v_mfma_f32_32x32x16_bf16 v[16:31], v[52:55], v[48:51], v[16:31]
    ds_read_b64_tr_b16 v[86:87], v13 offset:5120
    ds_read_b128 v[88:91], v12 offset:3072
    ds_read_b64_tr_b16 v[92:93], v13 offset:6144
    ds_read_b64_tr_b16 v[94:95], v13 offset:7168
    v_mfma_f32_32x32x16_bf16 v[16:31], v[60:63], v[56:59], v[16:31]
    s_add_u32 s33, s33, 16384
    s_cmp_eq_u32 s33, 65536
    s_cselect_b32 s33, 0, s33
    s_add_u32 s35, s35, 8192
    s_cmp_eq_u32 s35, 98304
    s_cselect_b32 s35, 0, s35
    v_add_u32 v12, s33, v10
    v_add_u32 v13, s35, v11
    s_sub_u32 s34, s34, 1
    s_waitcnt lgkmcnt(0)
    s_barrier
    v_mfma_f32_32x32x16_bf16 v[16:31], v[68:71], v[64:67], v[16:31]
    ds_read_b128 v[32:35], v12 offset:0
    ds_read_b64_tr_b16 v[36:37], v13 offset:0
    ds_read_b64_tr_b16 v[38:39], v13 offset:1024
    ds_read_b128 v[40:43], v12 offset:1024
    v_mfma_f32_32x32x16_bf16 v[16:31], v[76:79], v[72:75], v[16:31]
    ds_read_b64_tr_b16 v[44:45], v13 offset:2048
    ds_read_b64_tr_b16 v[46:47], v13 offset:3072
    ds_read_b128 v[48:51], v12 offset:2048
    ds_read_b64_tr_b16 v[52:53], v13 offset:4096
    v_mfma_f32_32x32x16_bf16 v[16:31], v[84:87], v[80:83], v[16:31]
    ds_read_b64_tr_b16 v[54:55], v13 offset:5120
    ds_read_b128 v[56:59], v12 offset:3072
    ds_read_b64_tr_b16 v[60:61], v13 offset:6144
    ds_read_b64_tr_b16 v[62:63], v13 offset:7168
    v_mfma_f32_32x32x16_bf16 v[16:31], v[92:95], v[88:91], v[16:31]
    s_cmp_eq_u32 s34, 0
    s_cbranch_scc1 Lgx_62
    s_add_u32 s33, s33, 16384
    s_cmp_eq_u32 s33, 65536
    s_cselect_b32 s33, 0, s33
    s_add_u32 s35, s35, 8192
    s_cmp_eq_u32 s35, 98304
    s_cselect_b32 s35, 0, s35
    v_add_u32 v12, s33, v10
    v_add_u32 v13, s35, v11
    s_branch Lgl_61
Lgx_62:
    s_add_u32 s35, s35, 8192
    s_cmp_eq_u32 s35, 98304
    s_cselect_b32 s35, 0, s35
    v_add_u32 v13, s35, v11
    s_waitcnt lgkmcnt(0)
    s_barrier
    v_mfma_f32_32x32x16_bf16 v[16:31], v[36:39], v[32:35], v[16:31]
    ds_read_b128 v[64:67], v12 offset:8192
    ds_read_b64_tr_b16 v[68:69], v13 offset:0
    ds_read_b64_tr_b16 v[70:71], v13 offset:1024
    ds_read_b128 v[72:75], v12 offset:9216
    v_mfma_f32_32x32x16_bf16 v[16:31], v[44:47], v[40:43], v[16:31]
    ds_read_b64_tr_b16 v[76:77], v13 offset:2048
    ds_read_b64_tr_b16 v[78:79], v13 offset:3072
    ds_read_b128 v[80:83], v12 offset:10240
    ds_read_b64_tr_b16 v[84:85], v13 offset:4096
    v_mfma_f32_32x32x16_bf16 v[16:31], v[52:55], v[48:51], v[16:31]
    ds_read_b64_tr_b16 v[86:87], v13 offset:5120
    ds_read_b128 v[88:91], v12 offset:11264
    ds_read_b64_tr_b16 v[92:93], v13 offset:6144
    ds_read_b64_tr_b16 v[94:95], v13 offset:7168
    v_mfma_f32_32x32x16_bf16 v[16:31], v[60:63], v[56:59], v[16:31]
    s_add_u32 s33, s33, 16384
    s_cmp_eq_u32 s33, 65536
    s_cselect_b32 s33, 0, s33
    s_add_u32 s35, s35, 8192
    s_cmp_eq_u32 s35, 98304
    s_cselect_b32 s35, 0, s35
    v_add_u32 v12, s33, v10
    v_add_u32 v13, s35, v11
    s_waitcnt lgkmcnt(0)
    s_barrier
    v_mfma_f32_32x32x16_bf16 v[16:31], v[68:71], v[64:67], v[16:31]
    ds_read_b128 v[32:35], v12 offset:0
    ds_read_b64_tr_b16 v[36:37], v13 offset:0
    ds_read_b64_tr_b16 v[38:39], v13 offset:1024
    ds_read_b128 v[40:43], v12 offset:1024
    v_mfma_f32_32x32x16_bf16 v[16:31], v[76:79], v[72:75], v[16:31]
    ds_read_b64_tr_b16 v[44:45], v13 offset:2048
    ds_read_b64_tr_b16 v[46:47], v13 offset:3072
    ds_read_b128 v[48:51], v12 offset:2048
    ds_read_b64_tr_b16 v[52:53], v13 offset:4096
    v_mfma_f32_32x32x16_bf16 v[16:31], v[84:87], v[80:83], v[16:31]
    ds_read_b64_tr_b16 v[54:55], v13 offset:5120
    ds_read_b128 v[56:59], v12 offset:3072
    ds_read_b64_tr_b16 v[60:61], v13 offset:6144
    ds_read_b64_tr_b16 v[62:63], v13 offset:7168
    v_mfma_f32_32x32x16_bf16 v[16:31], v[92:95], v[88:91], v[16:31]
    s_add_u32 s35, s35, 8192
    s_cmp_eq_u32 s35, 98304
    s_cselect_b32 s35, 0, s35
    v_add_u32 v13, s35, v11
    s_waitcnt lgkmcnt(0)
    s_barrier
    v_mfma_f32_32x32x16_bf16 v[16:31], v[36:39], v[32:35], v[16:31]
    ds_read_b128 v[64:67], v12 offset:8192
    ds_read_b64_tr_b16 v[68:69], v13 offset:0
    ds_read_b64_tr_b16 v[70:71], v13 offset:1024
    ds_read_b128 v[72:75], v12 offset:9216
    v_mfma_f32_32x32x16_bf16 v[16:31], v[44:47], v[40:43], v[16:31]
    ds_read_b64_tr_b16 v[76:77], v13 offset:2048
    ds_read_b64_tr_b16 v[78:79], v13 offset:3072
    ds_read_b128 v[80:83], v12 offset:10240
    ds_read_b64_tr_b16 v[84:85], v13 offset:4096
    v_mfma_f32_32x32x16_bf16 v[16:31], v[52:55], v[48:51], v[16:31]
    ds_read_b64_tr_b16 v[86:87], v13 offset:5120
    ds_read_b128 v[88:91], v12 offset:11264
    ds_read_b64_tr_b16 v[92:93], v13 offset:6144
    ds_read_b64_tr_b16 v[94:95], v13 offset:7168
    v_mfma_f32_32x32x16_bf16 v[16:31], v[60:63], v[56:59], v[16:31]
    s_waitcnt lgkmcnt(6)
    v_mfma_f32_32x32x16_bf16 v[16:31], v[68:71], v[64:67], v[16:31]
    ds_read_b128 v[96:99], v14 offset:0
    ds_read_b128 v[100:103], v14 offset:1024
    ds_read_b128 v[104:107], v14 offset:2048
    ds_read_b128 v[108:111], v14 offset:3072
    ds_read_b128 v[112:115], v14 offset:16384
    ds_read_b128 v[116:119], v14 offset:17408
    ds_read_b128 v[120:123], v14 offset:18432
    ds_read_b128 v[124:127], v14 offset:19456
    v_mfma_f32_32x32x16_bf16 v[16:31], v[76:79], v[72:75], v[16:31]
    s_waitcnt lgkmcnt(11)
    v_mfma_f32_32x32x16_bf16 v[16:31], v[84:87], v[80:83], v[16:31]
    s_waitcnt lgkmcnt(8)
    v_mfma_f32_32x32x16_bf16 v[16:31], v[92:95], v[88:91], v[16:31]
    s_waitcnt lgkmcnt(0)
    v_add_f32 v96, v96, v112
    v_add_f32 v97, v97, v113
    v_add_f32 v98, v98, v114
    v_add_f32 v99, v99, v115
    v_add_f32 v100, v100, v116
    v_add_f32 v101, v101, v117
    v_add_f32 v102, v102, v118
    v_add_f32 v103, v103, v119
    v_add_f32 v104, v104, v120
    v_add_f32 v105, v105, v121
    v_add_f32 v106, v106, v122
    v_add_f32 v107, v107, v123
    v_add_f32 v108, v108, v124
    v_add_f32 v109, v109, v125
    v_add_f32 v110, v110, v126
    v_add_f32 v111, v111, v127
    v_fma_f32 v96, v96, v152, v136
    v_fma_f32 v97, v97, v152, v137
    v_fma_f32 v98, v98, v152, v138
    v_fma_f32 v99, v99, v152, v139
    v_fma_f32 v100, v100, v152, v140
    v_fma_f32 v101, v101, v152, v141
    v_fma_f32 v102, v102, v152, v142
    v_fma_f32 v103, v103, v152, v143
    v_fma_f32 v104, v104, v152, v144
    v_fma_f32 v105, v105, v152, v145
    v_fma_f32 v106, v106, v152, v146
    v_fma_f32 v107, v107, v152, v147
    v_fma_f32 v108, v108, v152, v148
    v_fma_f32 v109, v109, v152, v149
    v_fma_f32 v110, v110, v152, v150
    v_fma_f32 v111, v111, v152, v151
    v_fma_f32 v16, v16, v152, v96
    v_fma_f32 v17, v17, v152, v97
    v_fma_f32 v18, v18, v152, v98
    v_fma_f32 v19, v19, v152, v99
    v_fma_f32 v20, v20, v152, v100
    v_fma_f32 v21, v21, v152, v101
    v_fma_f32 v22, v22, v152, v102
    v_fma_f32 v23, v23, v152, v103
    v_cvt_pk_bf16_f32 v128, v16, v17
    v_cvt_pk_bf16_f32 v129, v18, v19
    v_cvt_pk_bf16_f32 v130, v20, v21
    v_cvt_pk_bf16_f32 v131, v22, v23
    s_nop 1
    v_permlane32_swap_b32 v128, v130
    v_permlane32_swap_b32 v129, v131
    buffer_store_dwordx4 v[128:131], v15, s[16:19], s38 offen offset:0
    v_fma_f32 v24, v24, v152, v104
    v_fma_f32 v25, v25, v152, v105
    v_fma_f32 v26, v26, v152, v106
    v_fma_f32 v27, v27, v152, v107
    v_fma_f32 v28, v28, v152, v108
    v_fma_f32 v29, v29, v152, v109
    v_fma_f32 v30, v30, v152, v110
    v_fma_f32 v31, v31, v152, v111
    v_cvt_pk_bf16_f32 v132, v24, v25
    v_cvt_pk_bf16_f32 v133, v26, v27
    v_cvt_pk_bf16_f32 v134, v28, v29
    v_cvt_pk_bf16_f32 v135, v30, v31
    s_nop 1
    v_permlane32_swap_b32 v132, v134
    v_permlane32_swap_b32 v133, v135
    buffer_store_dwordx4 v[132:135], v15, s[16:19], s38 offen offset:32
    s_endpgm
LhiE_60:
    s_add_u32 m0, s33, 98304
    s_add_u32 s32, s41, 49152
    buffer_load_dwordx4 v2, s[12:15], s32 offen sc1 lds
    s_add_u32 m0, s33, 102400
    s_add_u32 s32, s41, 163840
    buffer_load_dwordx4 v2, s[12:15], s32 offen sc1 lds
    s_add_u32 m0, s33, 106496
    s_add_u32 s32, s41, 0
    buffer_load_dwordx4 v2, s[12:15], s32 offen sc1 lds
    s_add_u32 m0, s33, 110592
    s_add_u32 s32, s41, 114688
    buffer_load_dwordx4 v2, s[12:15], s32 offen sc1 lds
    s_add_u32 s41, s41, 4096
    s_add_u32 m0, s33, 114688
    s_add_u32 s32, s41, 49152
    buffer_load_dwordx4 v2, s[12:15], s32 offen sc1 lds
    s_add_u32 m0, s33, 118784
    s_add_u32 s32, s41, 163840
    buffer_load_dwordx4 v2, s[12:15], s32 offen sc1 lds
    s_add_u32 m0, s33, 122880
    s_add_u32 s32, s41, 0
    buffer_load_dwordx4 v2, s[12:15], s32 offen sc1 lds
    s_add_u32 m0, s33, 126976
    s_add_u32 s32, s41, 114688
    buffer_load_dwordx4 v2, s[12:15], s32 offen sc1 lds
    s_add_u32 s41, s41, 4096
    s_add_u32 m0, s33, 131072
    s_add_u32 s32, s41, 49152
    buffer_load_dwordx4 v2, s[12:15], s32 offen sc1 lds
    s_add_u32 m0, s33, 135168
    s_add_u32 s32, s41, 163840
    buffer_load_dwordx4 v2, s[12:15], s32 offen sc1 lds
    s_add_u32 m0, s33, 139264
    s_add_u32 s32, s41, 0
    buffer_load_dwordx4 v2, s[12:15], s32 offen sc1 lds
    s_add_u32 m0, s33, 143360
    s_add_u32 s32, s41, 114688
    buffer_load_dwordx4 v2, s[12:15], s32 offen sc1 lds
    s_add_u32 s41, s41, 4096
    s_waitcnt vmcnt(8)
    s_barrier
    s_add_u32 m0, s33, 147456
    s_add_u32 s32, s41, 49152
    buffer_load_dwordx4 v2, s[12:15], s32 offen sc1 lds
    s_add_u32 m0, s33, 151552
    s_add_u32 s32, s41, 163840
    buffer_load_dwordx4 v2, s[12:15], s32 offen sc1 lds
    s_add_u32 m0, s33, 155648
    s_add_u32 s32, s41, 0
    buffer_load_dwordx4 v2, s[12:15], s32 offen sc1 lds
    s_add_u32 m0, s33, 159744
    s_add_u32 s32, s41, 114688
    buffer_load_dwordx4 v2, s[12:15], s32 offen sc1 lds
    s_add_u32 s41, s41, 4096
    s_waitcnt vmcnt(8)
    s_barrier
    s_add_u32 m0, s33, 98304
    s_add_u32 s32, s41, 49152
    buffer_load_dwordx4 v2, s[12:15], s32 offen sc1 lds
    s_add_u32 m0, s33, 102400
    s_add_u32 s32, s41, 163840
    buffer_load_dwordx4 v2, s[12:15], s32 offen sc1 lds
    s_add_u32 m0, s33, 106496
    s_add_u32 s32, s41, 0
    buffer_load_dwordx4 v2, s[12:15], s32 offen sc1 lds
    s_add_u32 m0, s33, 110592
    s_add_u32 s32, s41, 114688
    buffer_load_dwordx4 v2, s[12:15], s32 offen sc1 lds
    s_add_u32 s41, s41, 4096
    s_add_u32 m0, s35, 0
    s_add_u32 s32, s40, 0
    buffer_load_dwordx4 v14, s[16:19], s32 offen lds
    s_add_u32 m0, s35, 1024
    s_add_u32 s32, s40, 8192
    buffer_load_dwordx4 v14, s[16:19], s32 offen lds
    s_add_u32 s40, s40, 65536
    s_waitcnt vmcnt(10)
    s_barrier
    s_add_u32 m0, s33, 114688
    s_add_u32 s32, s41, 49152
    buffer_load_dwordx4 v2, s[12:15], s32 offen sc1 lds
    s_add_u32 m0, s33, 118784
    s_add_u32 s32, s41, 163840
    buffer_load_dwordx4 v2, s[12:15], s32 offen sc1 lds
    s_add_u32 m0, s33, 122880
    s_add_u32 s32, s41, 0
    buffer_load_dwordx4 v2, s[12:15], s32 offen sc1 lds
    s_add_u32 m0, s33, 126976
    s_add_u32 s32, s41, 114688
    buffer_load_dwordx4 v2, s[12:15], s32 offen sc1 lds
    s_add_u32 s41, s41, 4096
    s_waitcnt vmcnt(10)
    s_barrier
    s_add_u32 m0, s33, 131072
    s_add_u32 s32, s41, 49152
    buffer_load_dwordx4 v2, s[12:15], s32 offen sc1 lds
    s_add_u32 m0, s33, 135168
    s_add_u32 s32, s41, 163840
    buffer_load_dwordx4 v2, s[12:15], s32 offen sc1 lds
    s_add_u32 m0, s33, 139264
    s_add_u32 s32, s41, 0
    buffer_load_dwordx4 v2, s[12:15], s32 offen sc1 lds
    s_add_u32 m0, s33, 143360
    s_add_u32 s32, s41, 114688
    buffer_load_dwordx4 v2, s[12:15], s32 offen sc1 lds
    s_add_u32 s41, s41, 4096
    s_add_u32 m0, s35, 8192
    s_add_u32 s32, s40, 0
    buffer_load_dwordx4 v14, s[16:19], s32 offen lds
    s_add_u32 m0, s35, 9216
    s_add_u32 s32, s40, 8192
    buffer_load_dwordx4 v14, s[16:19], s32 offen lds
    s_add_u32 s40, s40, 65536
    s_waitcnt vmcnt(12)
    s_barrier
    s_add_u32 m0, s33, 147456
    s_add_u32 s32, s41, 49152
    buffer_load_dwordx4 v2, s[12:15], s32 offen sc1 lds
    s_add_u32 m0, s33, 151552
    s_add_u32 s32, s41, 163840
    buffer_load_dwordx4 v2, s[12:15], s32 offen sc1 lds
    s_add_u32 m0, s33, 155648
    s_add_u32 s32, s41, 0
    buffer_load_dwordx4 v2, s[12:15], s32 offen sc1 lds
    s_add_u32 m0, s33, 159744
    s_add_u32 s32, s41, 114688
    buffer_load_dwordx4 v2, s[12:15], s32 offen sc1 lds
    s_add_u32 s41, s41, 4096
    s_waitcnt vmcnt(10)
    s_barrier
    s_add_u32 m0, s33, 98304
    s_add_u32 s32, s41, 49152
    buffer_load_dwordx4 v2, s[12:15], s32 offen sc1 lds
    s_add_u32 m0, s33, 102400
    s_add_u32 s32, s41, 163840
    buffer_load_dwordx4 v2, s[12:15], s32 offen sc1 lds
    s_add_u32 m0, s33, 106496
    s_add_u32 s32, s41, 0
    buffer_load_dwordx4 v2, s[12:15], s32 offen sc1 lds
    s_add_u32 m0, s33, 110592
    s_add_u32 s32, s41, 114688
    buffer_load_dwordx4 v2, s[12:15], s32 offen sc1 lds
    s_add_u32 s41, s41, 4096
    s_add_u32 m0, s35, 16384
    s_add_u32 s32, s40, 0
    buffer_load_dwordx4 v14, s[16:19], s32 offen lds
    s_add_u32 m0, s35, 17408
    s_add_u32 s32, s40, 8192
    buffer_load_dwordx4 v14, s[16:19], s32 offen lds
    s_add_u32 s40, s40, 65536
    s_waitcnt vmcnt(12)
    s_barrier
    s_add_u32 m0, s33, 114688
    s_add_u32 s32, s41, 49152
    buffer_load_dwordx4 v2, s[12:15], s32 offen sc1 lds
    s_add_u32 m0, s33, 118784
    s_add_u32 s32, s41, 163840
    buffer_load_dwordx4 v2, s[12:15], s32 offen sc1 lds
    s_add_u32 m0, s33, 122880
    s_add_u32 s32, s41, 0
    buffer_load_dwordx4 v2, s[12:15], s32 offen sc1 lds
    s_add_u32 m0, s33, 126976
    s_add_u32 s32, s41, 114688
    buffer_load_dwordx4 v2, s[12:15], s32 offen sc1 lds
    s_add_u32 s41, s41, 4096
    s_waitcnt vmcnt(10)
    s_barrier
    s_add_u32 m0, s33, 131072
    s_add_u32 s32, s41, 49152
    buffer_load_dwordx4 v2, s[12:15], s32 offen sc1 lds
    s_add_u32 m0, s33, 135168
    s_add_u32 s32, s41, 163840
    buffer_load_dwordx4 v2, s[12:15], s32 offen sc1 lds
    s_add_u32 m0, s33, 139264
    s_add_u32 s32, s41, 0
    buffer_load_dwordx4 v2, s[12:15], s32 offen sc1 lds
    s_add_u32 m0, s33, 143360
    s_add_u32 s32, s41, 114688
    buffer_load_dwordx4 v2, s[12:15], s32 offen sc1 lds
    s_add_u32 s41, s41, 4096
    s_add_u32 m0, s35, 24576
    s_add_u32 s32, s40, 0
    buffer_load_dwordx4 v14, s[16:19], s32 offen lds
    s_add_u32 m0, s35, 25600
    s_add_u32 s32, s40, 8192
    buffer_load_dwordx4 v14, s[16:19], s32 offen lds
    s_add_u32 s40, s40, 65536
    s_waitcnt vmcnt(12)
    s_barrier
    s_add_u32 m0, s33, 147456
    s_add_u32 s32, s41, 49152
    buffer_load_dwordx4 v2, s[12:15], s32 offen sc1 lds
    s_add_u32 m0, s33, 151552
    s_add_u32 s32, s41, 163840
    buffer_load_dwordx4 v2, s[12:15], s32 offen sc1 lds
    s_add_u32 m0, s33, 155648
    s_add_u32 s32, s41, 0
    buffer_load_dwordx4 v2, s[12:15], s32 offen sc1 lds
    s_add_u32 m0, s33, 159744
    s_add_u32 s32, s41, 114688
    buffer_load_dwordx4 v2, s[12:15], s32 offen sc1 lds
    s_add_u32 s41, s41, 4096
    s_waitcnt vmcnt(10)
    s_barrier
    s_add_u32 m0, s33, 98304
    s_add_u32 s32, s41, 49152
    buffer_load_dwordx4 v2, s[12:15], s32 offen sc1 lds
    s_add_u32 m0, s33, 102400
    s_add_u32 s32, s41, 163840
    buffer_load_dwordx4 v2, s[12:15], s32 offen sc1 lds
    s_add_u32 m0, s33, 106496
    s_add_u32 s32, s41, 53248
    buffer_load_dwordx4 v2, s[12:15], s32 offen sc1 lds
    s_add_u32 m0, s33, 110592
    s_add_u32 s32, s41, 167936
    buffer_load_dwordx4 v2, s[12:15], s32 offen sc1 lds
    s_add_u32 s41, s41, 4096
    s_waitcnt vmcnt(10)
    s_barrier
    s_add_u32 m0, s33, 114688
    s_add_u32 s32, s41, 53248
    buffer_load_dwordx4 v2, s[12:15], s32 offen sc1 lds
    s_add_u32 m0, s33, 118784
    s_add_u32 s32, s41, 167936
    buffer_load_dwordx4 v2, s[12:15], s32 offen sc1 lds
    s_add_u32 m0, s33, 122880
    s_add_u32 s32, s41, 57344
    buffer_load_dwordx4 v2, s[12:15], s32 offen sc1 lds
    s_add_u32 m0, s33, 126976
    s_add_u32 s32, s41, 172032
    buffer_load_dwordx4 v2, s[12:15], s32 offen sc1 lds
    s_add_u32 s41, s41, 4096
    s_waitcnt vmcnt(8)
    s_barrier
    s_waitcnt vmcnt(4)
    s_barrier
    s_barrier
    s_waitcnt vmcnt(0)
    s_barrier
    s_endpgm
Lloader:
    s_add_u32 s28, s56, s57
    s_and_b32 s28, s28, 7
    s_mul_i32 s28, s28, 196608
    s_lshl_b32 s29, s3, 3
    s_lshl_b32 s30, s57, 7
    s_lshl_b32 s33, s3, 10
    s_lshl_b32 s35, s3, 11
    s_mul_i32 s31, s3, 3072
    s_add_u32 s31, s31, 65536
    v_lshrrev_b32 v9, 3, v0
    v_add_u32 v9, s29, v9
    v_mul_u32_u24 v4, 3072, v9
    v_and_b32 v9, 7, v0
    v_bfe_u32 v10, v0, 4, 1
    v_lshlrev_b32 v10, 2, v10
    v_xor_b32 v9, v9, v10
    v_lshl_add_u32 v4, v9, 4, v4
    v_add_u32 v4, s30, v4
    s_waitcnt lgkmcnt(0)
    s_mov_b32 s16, s66
    s_mov_b32 s17, s67
    s_mov_b32 s18, 1572864
    s_mov_b32 s19, 0x00020000
    s_mov_b32 s12, s82
    s_mov_b32 s13, s83
    s_mov_b32 s14, 20971520
    s_mov_b32 s15, 0x00020000
    s_barrier
    s_add_u32 m0, s31, 0
    s_add_u32 s32, s28, 98304
    buffer_load_dwordx4 v4, s[16:19], s28 offen offset:0  lds
    buffer_load_dwordx4 v4, s[16:19], s28 offen offset:1024  lds
    buffer_load_dwordx4 v4, s[16:19], s28 offen offset:2048  lds
    s_add_u32 m0, s31, 12288
    s_add_u32 s28, s28, 196608
    s_cmp_eq_u32 s28, 1572864
    s_cselect_b32 s28, 0, s28
    buffer_load_dwordx4 v4, s[16:19], s32 offen offset:0  lds
    buffer_load_dwordx4 v4, s[16:19], s32 offen offset:1024  lds
    buffer_load_dwordx4 v4, s[16:19], s32 offen offset:2048  lds
    s_add_u32 m0, s31, 24576
    s_add_u32 s32, s28, 98304
    buffer_load_dwordx4 v4, s[16:19], s28 offen offset:0  lds
    buffer_load_dwordx4 v4, s[16:19], s28 offen offset:1024  lds
    buffer_load_dwordx4 v4, s[16:19], s28 offen offset:2048  lds
    s_add_u32 m0, s31, 36864
    s_add_u32 s28, s28, 196608
    s_cmp_eq_u32 s28, 1572864
    s_cselect_b32 s28, 0, s28
    buffer_load_dwordx4 v4, s[16:19], s32 offen offset:0  lds
    buffer_load_dwordx4 v4, s[16:19], s32 offen offset:1024  lds
    buffer_load_dwordx4 v4, s[16:19], s32 offen offset:2048  lds
    s_add_u32 m0, s31, 49152
    s_add_u32 s32, s28, 98304
    buffer_load_dwordx4 v4, s[16:19], s28 offen offset:0  lds
    buffer_load_dwordx4 v4, s[16:19], s28 offen offset:1024  lds
    buffer_load_dwordx4 v4, s[16:19], s28 offen offset:2048  lds
    s_add_u32 m0, s31, 61440
    s_add_u32 s28, s28, 196608
    s_cmp_eq_u32 s28, 1572864
    s_cselect_b32 s28, 0, s28
    buffer_load_dwordx4 v4, s[16:19], s32 offen offset:0  lds
    buffer_load_dwordx4 v4, s[16:19], s32 offen offset:1024  lds
    buffer_load_dwordx4 v4, s[16:19], s32 offen offset:2048  lds
    s_waitcnt vmcnt(12)
    s_barrier
    s_add_u32 m0, s31, 73728
    s_add_u32 s32, s28, 98304
    buffer_load_dwordx4 v4, s[16:19], s28 offen offset:0  lds
    buffer_load_dwordx4 v4, s[16:19], s28 offen offset:1024  lds
    buffer_load_dwordx4 v4, s[16:19], s28 offen offset:2048  lds
    s_add_u32 m0, s31, 86016
    s_add_u32 s28, s28, 196608
    s_cmp_eq_u32 s28, 1572864
    s_cselect_b32 s28, 0, s28
    buffer_load_dwordx4 v4, s[16:19], s32 offen offset:0  lds
    buffer_load_dwordx4 v4, s[16:19], s32 offen offset:1024  lds
    s_mov_b32 s36, s32
    s_waitcnt vmcnt(11)
    s_barrier
    s_add_u32 m0, s31, 86016
    s_nop 0
    buffer_load_dwordx4 v4, s[16:19], s36 offen offset:2048  lds
    s_add_u32 m0, s31, 0
    s_add_u32 s32, s28, 98304
    buffer_load_dwordx4 v4, s[16:19], s28 offen offset:0  lds
    buffer_load_dwordx4 v4, s[16:19], s28 offen offset:1024  lds
    buffer_load_dwordx4 v4, s[16:19], s28 offen offset:2048  lds
    s_add_u32 m0, s31, 12288
    s_add_u32 s28, s28, 196608
    s_cmp_eq_u32 s28, 1572864
    s_cselect_b32 s28, 0, s28
    buffer_load_dwordx4 v4, s[16:19], s32 offen offset:0  lds
    buffer_load_dwordx4 v4, s[16:19], s32 offen offset:1024  lds
    buffer_load_dwordx4 v4, s[16:19], s32 offen offset:2048  lds
    s_waitcnt vmcnt(12)
    s_barrier
    s_add_u32 m0, s31, 24576
    s_add_u32 s32, s28, 98304
    buffer_load_dwordx4 v4, s[16:19], s28 offen offset:0  lds
    buffer_load_dwordx4 v4, s[16:19], s28 offen offset:1024  lds
    buffer_load_dwordx4 v4, s[16:19], s28 offen offset:2048  lds
    s_add_u32 m0, s31, 36864
    s_add_u32 s28, s28, 196608
    s_cmp_eq_u32 s28, 1572864
    s_cselect_b32 s28, 0, s28
    buffer_load_dwordx4 v4, s[16:19], s32 offen offset:0  lds
    buffer_load_dwordx4 v4, s[16:19], s32 offen offset:1024  lds
    buffer_load_dwordx4 v4, s[16:19], s32 offen offset:2048  lds
    s_waitcnt vmcnt(12)
    s_barrier
    s_add_u32 m0, s31, 49152
    s_add_u32 s32, s28, 98304
    buffer_load_dwordx4 v4, s[16:19], s28 offen offset:0  lds
    buffer_load_dwordx4 v4, s[16:19], s28 offen offset:1024  lds
    buffer_load_dwordx4 v4, s[16:19], s28 offen offset:2048  lds
    s_add_u32 m0, s31, 61440
    s_add_u32 s28, s28, 196608
    s_cmp_eq_u32 s28, 1572864
    s_cselect_b32 s28, 0, s28
    buffer_load_dwordx4 v4, s[16:19], s32 offen offset:0  lds
    buffer_load_dwordx4 v4, s[16:19], s32 offen offset:1024  lds
    buffer_load_dwordx4 v4, s[16:19], s32 offen offset:2048  lds
    s_waitcnt vmcnt(12)
    s_barrier
    s_add_u32 m0, s31, 73728
    s_add_u32 s32, s28, 98304
    buffer_load_dwordx4 v4, s[16:19], s28 offen offset:0  lds
    buffer_load_dwordx4 v4, s[16:19], s28 offen offset:1024  lds
    buffer_load_dwordx4 v4, s[16:19], s28 offen offset:2048  lds
    s_add_u32 m0, s31, 86016
    s_add_u32 s28, s28, 196608
    s_cmp_eq_u32 s28, 1572864
    s_cselect_b32 s28, 0, s28
    buffer_load_dwordx4 v4, s[16:19], s32 offen offset:0  lds
    buffer_load_dwordx4 v4, s[16:19], s32 offen offset:1024  lds
    buffer_load_dwordx4 v4, s[16:19], s32 offen offset:2048  lds
    s_waitcnt vmcnt(12)
    s_barrier
    s_waitcnt vmcnt(6)
    s_barrier
    s_waitcnt vmcnt(0)
    s_barrier
    s_barrier
    s_barrier
    s_lshl_b32 s28, s24, 17
    s_add_u32 s28, s28, s33
    s_add_u32 s28, s28, 2097152
    s_lshl_b32 s29, s3, 2
    s_add_u32 s29, s29, 157696
    v_mov_b32 v22, s29
    v_mov_b32 v23, 0
    ds_write_b32 v22, v23
    s_mov_b32 s16, s68
    s_mov_b32 s17, s69
    s_mov_b32 s18, 524288
    s_mov_b32 s19, 0x00020000
    s_mov_b32 s36, s72
    s_mov_b32 s37, s73
    s_mov_b32 s38, 1835008
    s_mov_b32 s39, 0x00020000
    s_mov_b32 s48, s76
    s_mov_b32 s49, s77
    s_mov_b32 s50, 1835008
    s_mov_b32 s51, 0x00020000
    s_mov_b32 s52, s64
    s_mov_b32 s53, s65
    s_mov_b32 s54, 2097152
    s_mov_b32 s55, 0x00020000
    s_lshl_b32 s29, s3, 4
    s_lshl_b32 s30, s23, 7
    s_lshl_b32 s31, s22, 6
    s_add_u32 s31, s31, s29
    s_lshl_b32 s32, s27, 8
    v_lshrrev_b32 v5, 3, v0
    v_add_u32 v5, s29, v5
    v_mul_u32_u24 v4, 1024, v5
    v_and_b32 v5, 7, v0
    v_bfe_u32 v6, v0, 4, 1
    v_lshlrev_b32 v6, 2, v6
    v_xor_b32 v5, v5, v6
    v_lshl_add_u32 v4, v5, 4, v4
    v_add_u32 v4, s30, v4
    v_lshrrev_b32 v5, 3, v0
    v_add_u32 v5, s31, v5
    v_lshlrev_b32 v7, 10, v5
    v_add_u32 v7, s30, v7
    v_add_u32 v8, 8192, v7
    v_and_b32 v5, 7, v0
    v_lshrrev_b32 v6, 4, v0
    v_xor_b32 v5, v5, v6
    v_lshl_add_u32 v7, v5, 4, v7
    v_xor_b32 v5, 4, v5
    v_lshl_add_u32 v8, v5, 4, v8
    v_lshrrev_b32 v5, 3, v0
    v_add_u32 v5, s29, v5
    v_mul_u32_u24 v9, 3584, v5
    v_and_b32 v5, 7, v0
    v_bfe_u32 v6, v0, 4, 1
    v_lshlrev_b32 v6, 2, v6
    v_xor_b32 v5, v5, v6
    v_lshl_add_u32 v9, v5, 4, v9
    v_add_u32 v9, s32, v9
    v_lshlrev_b32 v5, 7, v0
    v_lshrrev_b32 v11, 4, v0
    v_mul_u32_u24 v11, 3584, v11
    v_and_b32 v12, 15, v0
    v_min_u32 v12, 13, v12
    v_lshl_add_u32 v11, v12, 7, v11
    s_lshl_b32 s41, s21, 2
    s_add_u32 s41, s41, s3
    s_lshl_b32 s42, s41, 13
    s_mul_i32 s40, s41, 14336
    s_lshr_b32 s45, s20, 2
    s_mul_i32 s45, s45, 1792
    s_add_u32 s40, s40, s45
    s_add_u32 s47, s42, 786432
    s_lshl_b32 s44, s20, 6
    s_add_u32 s44, s44, s29
    s_min_u32 s45, s21, 27
    s_lshl_b32 s45, s45, 7
    v_lshrrev_b32 v19, 3, v0
    v_add_u32 v19, s44, v19
    v_mul_u32_u24 v18, 3584, v19
    v_and_b32 v19, 7, v0
    v_bfe_u32 v20, v0, 4, 1
    v_lshlrev_b32 v20, 2, v20
    v_xor_b32 v19, v19, v20
    v_lshl_add_u32 v18, v19, 4, v18
    v_add_u32 v18, s45, v18
    s_mov_b32 s45, 0
    v_mul_u32_u24 v19, 512, v1
    v_bfe_u32 v20, v0, 2, 2
    v_lshl_add_u32 v19, v20, 7, v19
    v_bfe_u32 v20, v0, 4, 1
    v_lshlrev_b32 v20, 5, v20
    v_and_b32 v21, 3, v0
    v_lshl_add_u32 v20, v21, 3, v20
    v_add_u32 v20, s45, v20
    v_bfe_u32 v21, v0, 3, 1
    v_lshlrev_b32 v21, 6, v21
    v_xor_b32 v20, v20, v21
    v_add_u32 v19, v19, v20
    v_add_u32 v19, 141312, v19
    v_add_u32 v19, s35, v19
    v_xor_b32 v21, 64, v19
    v_mov_b32 v24, 0x3f803f80
    v_mov_b32 v25, 0x3f803f80
    v_mov_b32 v26, 0x3f803f80
    v_mov_b32 v27, 0x3f803f80
    s_lshl_b32 s44, s20, 2
    s_add_u32 s44, s44, s3
    s_mul_i32 s44, s44, 7168
    s_lshl_b32 s45, s21, 8
    s_add_u32 s44, s44, s45
    s_add_u32 s44, s44, 11010048
    v_lshlrev_b32 v20, 2, v3
    s_and_b32 s29, s3, 1
    s_lshr_b32 s31, s3, 1
    s_lshl_b32 s29, s29, 6
    s_lshl_b32 s32, s23, 7
    s_add_u32 s29, s29, s32
    s_lshl_b32 s31, s31, 15
    s_add_u32 s46, s29, s31
    v_lshrrev_b32 v10, 2, v0
    v_lshlrev_b32 v10, 10, v10
    v_and_b32 v12, 3, v0
    v_lshl_add_u32 v10, v12, 4, v10
    v_add_u32 v17, 16384, v10
    v_lshlrev_b32 v13, 8, v1
    v_bfe_u32 v6, v0, 2, 2
    v_lshl_add_u32 v13, v6, 6, v13
    v_bfe_u32 v6, v0, 4, 1
    v_lshl_add_u32 v13, v6, 5, v13
    v_lshl_add_u32 v13, v12, 3, v13
    s_add_u32 s29, s35, 141312
    v_add_u32 v13, s29, v13
    v_add_u32 v12, s29, v2
    v_mov_b32 v23, 1
    s_mov_b32 m0, s33
    s_mov_b32 s30, 29
    s_waitcnt lgkmcnt(0)
    s_setprio 3
    s_barrier
    buffer_load_dwordx4 v2, s[12:15], s28 offen sc1 lds
    s_add_u32 m0, m0, 4096
    s_add_u32 s28, s28, 4096
    buffer_load_dwordx4 v2, s[12:15], s28 offen sc1 lds
    s_add_u32 m0, m0, 4096
    s_add_u32 s28, s28, 4096
    buffer_load_dwordx4 v2, s[12:15], s28 offen sc1 lds
    s_add_u32 m0, m0, 4096
    s_add_u32 s28, s28, 4096
    s_waitcnt vmcnt(2)
    ds_write_b32 v22, v23
    s_mov_b32 s31, -2
Lrd_63:
    buffer_load_dwordx4 v2, s[12:15], s28 offen sc1 lds
    s_add_u32 m0, m0, 4096
    s_add_u32 s28, s28, 4096
    s_add_u32 s31, s31, 1
    s_max_i32 s32, s31, 1
    v_mov_b32 v23, s32
    s_waitcnt vmcnt(5)
    ds_write_b32 v22, v23
    s_sub_u32 s30, s30, 1
    s_cmp_lg_u32 s30, 0
    s_cbranch_scc1 Lrd_63
    v_mov_b32 v23, 32
    s_waitcnt vmcnt(0)
    ds_write_b32 v22, v23
    buffer_load_dword v14, v5, s[16:19], s42 offen
    buffer_load_dword v15, v11, s[36:39], s40 offen
    buffer_load_dword v16, v5, s[48:51], s47 offen
    s_add_u32 m0, s35, 149504
    s_mov_b32 s45, 28672
    buffer_load_dwordx4 v7, s[52:55], 0 offen lds
    s_add_u32 m0, s35, 150528
    s_nop 0
    buffer_load_dwordx4 v8, s[52:55], 0 offen lds
    s_cmp_ge_u32 s2, 224
    s_cbranch_scc1 Lnosl_64
    s_add_u32 m0, s35, 141312
    s_nop 0
    buffer_load_dwordx4 v18, s[36:39], 0 offen lds
    s_add_u32 m0, s35, 142336
    s_nop 0
    buffer_load_dwordx4 v18, s[36:39], s45 offen lds
    s_waitcnt vmcnt(0)
    ds_read_b64_tr_b16 v[28:29], v19
    ds_read_b64_tr_b16 v[30:31], v19 offset:1024
    ds_read_b64_tr_b16 v[32:33], v21
    ds_read_b64_tr_b16 v[34:35], v21 offset:1024
    s_waitcnt lgkmcnt(0)
    v_mfma_f32_32x32x16_bf16 v[36:51], v[24:27], v[28:31], 0
    v_mfma_f32_32x32x16_bf16 v[52:67], v[24:27], v[32:35], 0
    s_nop 15
    s_mov_b32 exec_hi, 0
    buffer_store_dword v36, v20, s[12:15], s44 offen sc1
    buffer_store_dword v52, v20, s[12:15], s44 offen offset:128 sc1
    s_mov_b64 exec, -1
Lnosl_64:
    buffer_load_dwordx4 v[72:75], v10, s[48:51], s46 offen
    buffer_load_dwordx4 v[76:79], v17, s[48:51], s46 offen
    s_add_u32 s46, s46, 65536
    buffer_load_dwordx4 v[80:83], v10, s[48:51], s46 offen
    buffer_load_dwordx4 v[84:87], v17, s[48:51], s46 offen
    s_add_u32 s46, s46, 65536
    buffer_load_dwordx4 v[88:91], v10, s[48:51], s46 offen
    buffer_load_dwordx4 v[92:95], v17, s[48:51], s46 offen
    s_add_u32 s46, s46, 65536
    buffer_load_dwordx4 v[96:99], v10, s[48:51], s46 offen
    buffer_load_dwordx4 v[100:103], v17, s[48:51], s46 offen
    s_add_u32 s46, s46, 65536
    buffer_load_dwordx4 v[104:107], v10, s[48:51], s46 offen
    buffer_load_dwordx4 v[108:111], v17, s[48:51], s46 offen
    s_add_u32 s46, s46, 65536
    buffer_load_dwordx4 v[112:115], v10, s[48:51], s46 offen
    buffer_load_dwordx4 v[116:119], v17, s[48:51], s46 offen
    s_add_u32 s46, s46, 65536
    buffer_load_dwordx4 v[120:123], v10, s[48:51], s46 offen
    buffer_load_dwordx4 v[124:127], v17, s[48:51], s46 offen
    s_add_u32 s46, s46, 65536
    buffer_load_dwordx4 v[128:131], v10, s[48:51], s46 offen
    buffer_load_dwordx4 v[132:135], v17, s[48:51], s46 offen
    s_add_u32 s46, s46, 65536
    buffer_load_dwordx4 v[136:139], v10, s[48:51], s46 offen
    buffer_load_dwordx4 v[140:143], v17, s[48:51], s46 offen
    s_add_u32 s46, s46, 65536
    buffer_load_dwordx4 v[144:147], v10, s[48:51], s46 offen
    buffer_load_dwordx4 v[148:151], v17, s[48:51], s46 offen
    s_add_u32 s46, s46, 65536
    buffer_load_dwordx4 v[152:155], v10, s[48:51], s46 offen
    buffer_load_dwordx4 v[156:159], v17, s[48:51], s46 offen
    s_add_u32 s46, s46, 65536
    buffer_load_dwordx4 v[160:163], v10, s[48:51], s46 offen
    buffer_load_dwordx4 v[164:167], v17, s[48:51], s46 offen
    s_add_u32 s46, s46, 65536
    s_waitcnt vmcnt(0)
    s_barrier
    s_barrier
    s_setprio 0
    s_mov_b32 s40, 0
    s_mul_i32 s41, s22, 65536
    s_add_u32 s41, s41, s33
    s_add_u32 s41, s41, 6291456
    s_add_u32 m0, s35, 0
    s_add_u32 s32, s40, 0
    buffer_load_dwordx4 v4, s[16:19], s32 offen  lds
    s_add_u32 m0, s35, 1024
    s_add_u32 s32, s40, 8192
    buffer_load_dwordx4 v4, s[16:19], s32 offen  lds
    s_add_u32 s40, s40, 65536
    s_add_u32 m0, s35, 8192
    s_add_u32 s32, s40, 0
    buffer_load_dwordx4 v4, s[16:19], s32 offen  lds
    s_add_u32 m0, s35, 9216
    s_add_u32 s32, s40, 8192
    buffer_load_dwordx4 v4, s[16:19], s32 offen  lds
    s_add_u32 s40, s40, 65536
    s_add_u32 m0, s35, 16384
    s_add_u32 s32, s40, 0
    buffer_load_dwordx4 v4, s[16:19], s32 offen  lds
    s_add_u32 m0, s35, 17408
    s_add_u32 s32, s40, 8192
    buffer_load_dwordx4 v4, s[16:19], s32 offen  lds
    s_add_u32 s40, s40, 65536
    s_add_u32 m0, s35, 24576
    s_add_u32 s32, s40, 0
    buffer_load_dwordx4 v4, s[16:19], s32 offen  lds
    s_add_u32 m0, s35, 25600
    s_add_u32 s32, s40, 8192
    buffer_load_dwordx4 v4, s[16:19], s32 offen  lds
    s_add_u32 s40, s40, 65536
    s_add_u32 m0, s35, 32768
    s_add_u32 s32, s40, 0
    buffer_load_dwordx4 v4, s[16:19], s32 offen  lds
    s_add_u32 m0, s35, 33792
    s_add_u32 s32, s40, 8192
    buffer_load_dwordx4 v4, s[16:19], s32 offen  lds
    s_add_u32 s40, s40, 65536
    s_add_u32 m0, s35, 40960
    s_add_u32 s32, s40, 0
    buffer_load_dwordx4 v4, s[16:19], s32 offen  lds
    s_add_u32 m0, s35, 41984
    s_add_u32 s32, s40, 8192
    buffer_load_dwordx4 v4, s[16:19], s32 offen  lds
    s_add_u32 s40, s40, 65536
    s_add_u32 m0, s35, 49152
    s_add_u32 s32, s40, 0
    buffer_load_dwordx4 v4, s[16:19], s32 offen  lds
    s_add_u32 m0, s35, 50176
    s_add_u32 s32, s40, 8192
    buffer_load_dwordx4 v4, s[16:19], s32 offen  lds
    s_add_u32 s40, s40, 65536
    s_add_u32 m0, s35, 57344
    s_add_u32 s32, s40, 0
    buffer_load_dwordx4 v4, s[16:19], s32 offen  lds
    s_add_u32 m0, s35, 58368
    s_add_u32 s32, s40, 8192
    buffer_load_dwordx4 v4, s[16:19], s32 offen  lds
    s_add_u32 s40, s40, 65536
    s_waitcnt vmcnt(63)
    s_barrier
    s_barrier
    s_setprio 3
    s_add_u32 m0, s33, 65536
    s_add_u32 s32, s41, 32768
    buffer_load_dwordx4 v2, s[12:15], s41 offen sc1  lds
    s_add_u32 m0, s33, 69632
    s_add_u32 s41, s41, 4096
    buffer_load_dwordx4 v2, s[12:15], s32 offen sc1  lds
    s_add_u32 m0, s33, 73728
    s_add_u32 s32, s41, 32768
    buffer_load_dwordx4 v2, s[12:15], s41 offen sc1  lds
    s_add_u32 m0, s33, 77824
    s_add_u32 s41, s41, 4096
    buffer_load_dwordx4 v2, s[12:15], s32 offen sc1  lds
    s_add_u32 m0, s33, 81920
    s_add_u32 s32, s41, 32768
    buffer_load_dwordx4 v2, s[12:15], s41 offen sc1  lds
    s_add_u32 m0, s33, 86016
    s_add_u32 s41, s41, 4096
    buffer_load_dwordx4 v2, s[12:15], s32 offen sc1  lds
    s_add_u32 m0, s33, 90112
    s_add_u32 s32, s41, 32768
    buffer_load_dwordx4 v2, s[12:15], s41 offen sc1  lds
    s_add_u32 m0, s33, 94208
    s_add_u32 s41, s41, 4096
    buffer_load_dwordx4 v2, s[12:15], s32 offen sc1  lds
    s_add_u32 m0, s33, 98304
    s_add_u32 s32, s41, 32768
    buffer_load_dwordx4 v2, s[12:15], s41 offen sc1  lds
    s_add_u32 m0, s33, 102400
    s_add_u32 s41, s41, 4096
    buffer_load_dwordx4 v2, s[12:15], s32 offen sc1  lds
    s_add_u32 m0, s33, 106496
    s_add_u32 s32, s41, 32768
    buffer_load_dwordx4 v2, s[12:15], s41 offen sc1  lds
    s_add_u32 m0, s33, 110592
    s_add_u32 s41, s41, 4096
    buffer_load_dwordx4 v2, s[12:15], s32 offen sc1  lds
    s_waitcnt vmcnt(10)
    s_barrier
    s_add_u32 m0, s33, 114688
    s_add_u32 s32, s41, 32768
    buffer_load_dwordx4 v2, s[12:15], s41 offen sc1  lds
    s_add_u32 m0, s33, 118784
    s_add_u32 s41, s41, 4096
    buffer_load_dwordx4 v2, s[12:15], s32 offen sc1  lds
    s_waitcnt vmcnt(10)
    s_barrier
    s_add_u32 m0, s33, 122880
    s_add_u32 s32, s41, 32768
    buffer_load_dwordx4 v2, s[12:15], s41 offen sc1  lds
    s_add_u32 m0, s33, 126976
    s_add_u32 s41, s41, 4096
    buffer_load_dwordx4 v2, s[12:15], s32 offen sc1  lds
    s_waitcnt vmcnt(10)
    s_barrier
    s_waitcnt vmcnt(8)
    s_barrier
    s_mov_b32 s16, s74
    s_mov_b32 s17, s75
    s_mov_b32 s18, 3584
    s_mov_b32 s19, 0x00020000
    s_min_u32 s44, s27, 13
    s_lshl_b32 s44, s44, 2
    s_add_u32 s44, s44, s3
    s_lshl_b32 s45, s44, 7
    s_add_u32 s45, s45, 11010048
    s_lshl_b32 s44, s44, 6
    v_lshrrev_b32 v12, 3, v0
    v_mul_u32_u24 v12, 7168, v12
    v_and_b32 v13, 7, v0
    v_lshl_add_u32 v12, v13, 4, v12
    v_lshlrev_b32 v14, 1, v3
    buffer_load_ushort v10, v14, s[16:19], s44 offen
    buffer_load_dwordx4 v[56:59], v12, s[12:15], s45 offen sc1
    s_add_u32 s45, s45, 57344
    buffer_load_dwordx4 v[60:63], v12, s[12:15], s45 offen sc1
    s_add_u32 s45, s45, 57344
    buffer_load_dwordx4 v[64:67], v12, s[12:15], s45 offen sc1
    s_add_u32 s45, s45, 57344
    buffer_load_dwordx4 v[68:71], v12, s[12:15], s45 offen sc1
    s_add_u32 s45, s45, 57344
    s_waitcnt vmcnt(11)
    s_barrier
    s_waitcnt vmcnt(9)
    s_barrier
    s_waitcnt vmcnt(7)
    s_barrier
    s_waitcnt vmcnt(5)
    s_barrier
    s_barrier
    s_setprio 0
    s_lshl_b32 s46, s21, 2
    s_add_u32 s46, s46, s3
    s_add_u32 s46, s46, 96
    s_lshl_b32 s46, s46, 13
    s_cmp_ge_u32 s2, 224
    s_cbranch_scc1 LldE0_66
    s_mov_b32 s40, 0
    s_lshl_b32 s41, s26, 2
    s_add_u32 s41, s41, s3
    s_lshl_b32 s43, s41, 12
    s_add_u32 s43, s43, 10485760
    s_lshl_b32 s41, s41, 15
    s_add_u32 s41, s41, 8388608
    s_lshl_b32 s42, s3, 12
    s_add_u32 m0, s35, 0
    s_add_u32 s32, s40, 0
    buffer_load_dwordx4 v9, s[36:39], s32 offen  lds
    s_add_u32 m0, s35, 1024
    s_add_u32 s32, s40, 28672
    buffer_load_dwordx4 v9, s[36:39], s32 offen  lds
    s_add_u32 m0, s35, 8192
    s_add_u32 s32, s40, 128
    buffer_load_dwordx4 v9, s[36:39], s32 offen  lds
    s_add_u32 m0, s35, 9216
    s_add_u32 s32, s40, 28800
    buffer_load_dwordx4 v9, s[36:39], s32 offen  lds
    s_add_u32 s40, s40, 229376
    s_waitcnt vmcnt(4)
    s_add_u32 m0, s35, 16384
    s_add_u32 s32, s40, 0
    buffer_load_dwordx4 v9, s[36:39], s32 offen  lds
    s_add_u32 m0, s35, 17408
    s_add_u32 s32, s40, 28672
    buffer_load_dwordx4 v9, s[36:39], s32 offen  lds
    s_add_u32 m0, s35, 24576
    s_add_u32 s32, s40, 128
    buffer_load_dwordx4 v9, s[36:39], s32 offen  lds
    s_add_u32 m0, s35, 25600
    s_add_u32 s32, s40, 28800
    buffer_load_dwordx4 v9, s[36:39], s32 offen  lds
    s_add_u32 s40, s40, 229376
    s_waitcnt vmcnt(4)
    s_barrier
    s_barrier
    s_add_u32 m0, s35, 32768
    s_add_u32 s32, s40, 0
    buffer_load_dwordx4 v9, s[36:39], s32 offen  lds
    s_add_u32 m0, s35, 33792
    s_add_u32 s32, s40, 28672
    buffer_load_dwordx4 v9, s[36:39], s32 offen  lds
    s_add_u32 m0, s35, 40960
    s_add_u32 s32, s40, 128
    buffer_load_dwordx4 v9, s[36:39], s32 offen  lds
    s_add_u32 m0, s35, 41984
    s_add_u32 s32, s40, 28800
    buffer_load_dwordx4 v9, s[36:39], s32 offen  lds
    s_add_u32 s40, s40, 229376
    s_waitcnt vmcnt(4)
    s_add_u32 m0, s35, 49152
    s_add_u32 s32, s40, 0
    buffer_load_dwordx4 v9, s[36:39], s32 offen  lds
    s_add_u32 m0, s35, 50176
    s_add_u32 s32, s40, 28672
    buffer_load_dwordx4 v9, s[36:39], s32 offen  lds
    s_add_u32 m0, s35, 57344
    s_add_u32 s32, s40, 128
    buffer_load_dwordx4 v9, s[36:39], s32 offen  lds
    s_add_u32 m0, s35, 58368
    s_add_u32 s32, s40, 28800
    buffer_load_dwordx4 v9, s[36:39], s32 offen  lds
    s_add_u32 s40, s40, 229376
    s_waitcnt vmcnt(4)
    s_add_u32 m0, s35, 65536
    s_add_u32 s32, s40, 0
    buffer_load_dwordx4 v9, s[36:39], s32 offen  lds
    s_add_u32 m0, s35, 66560
    s_add_u32 s32, s40, 28672
    buffer_load_dwordx4 v9, s[36:39], s32 offen  lds
    s_add_u32 m0, s35, 73728
    s_add_u32 s32, s40, 128
    buffer_load_dwordx4 v9, s[36:39], s32 offen  lds
    s_add_u32 m0, s35, 74752
    s_add_u32 s32, s40, 28800
    buffer_load_dwordx4 v9, s[36:39], s32 offen  lds
    s_add_u32 s40, s40, 229376
    s_waitcnt vmcnt(63)
    s_barrier
    v_add_f32 v56, v56, v60
    v_add_f32 v64, v64, v68
    v_add_f32 v57, v57, v61
    v_add_f32 v65, v65, v69
    v_add_f32 v58, v58, v62
    v_add_f32 v66, v66, v70
    v_add_f32 v59, v59, v63
    v_add_f32 v67, v67, v71
    v_add_f32 v56, v56, v64
    v_add_f32 v57, v57, v65
    v_add_f32 v58, v58, v66
    v_add_f32 v59, v59, v67
    v_add_u32 v11, s33, v2
    v_add_u32 v11, 147456, v11
    ds_write_b128 v11, v[56:59]
    v_lshlrev_b32 v12, 9, v1
    v_lshl_add_u32 v12, v3, 2, v12
    v_add_u32 v12, s33, v12
    v_add_u32 v12, 147456, v12
    v_cmp_gt_u32 vcc, 32, v0
    s_waitcnt lgkmcnt(0)
    ds_read2_b32 v[56:57], v12 offset0:0 offset1:32
    ds_read2_b32 v[58:59], v12 offset0:64 offset1:96
    v_cndmask_b32 v60, 0, v10, vcc
    s_waitcnt lgkmcnt(0)
    v_add_f32 v56, v56, v57
    v_add_f32 v58, v58, v59
    v_add_f32 v56, v56, v58
    v_cvt_pk_bf16_f32 v42, v56, v56
    v_and_b32 v40, 0xffff0000, v42
    v_sub_f32 v41, v56, v40
    v_cvt_pk_bf16_f32 v48, v40, v40
    v_cvt_pk_bf16_f32 v49, v41, 0
    v_lshl_or_b32 v49, v60, 16, v49
    v_mov_b32 v50, v60
    v_mov_b32 v51, 0
    ds_write_b128 v11, v[48:51]
    s_setprio 3
    s_barrier
    s_add_u32 m0, s42, 81920
    s_nop 0
    buffer_load_dwordx4 v2, s[12:15], s41 offen offset:0 sc1  lds
    buffer_load_dwordx4 v2, s[12:15], s41 offen offset:1024 sc1  lds
    buffer_load_dwordx4 v2, s[12:15], s41 offen offset:2048 sc1  lds
    buffer_load_dwordx4 v2, s[12:15], s41 offen offset:3072 sc1  lds
    s_add_u32 s41, s41, 4096
    s_add_u32 m0, s42, 98304
    s_nop 0
    buffer_load_dwordx4 v2, s[12:15], s41 offen offset:0 sc1  lds
    buffer_load_dwordx4 v2, s[12:15], s41 offen offset:1024 sc1  lds
    buffer_load_dwordx4 v2, s[12:15], s41 offen offset:2048 sc1  lds
    buffer_load_dwordx4 v2, s[12:15], s41 offen offset:3072 sc1  lds
    s_add_u32 s41, s41, 4096
    s_add_u32 m0, s42, 114688
    s_nop 0
    buffer_load_dwordx4 v2, s[12:15], s41 offen offset:0 sc1  lds
    buffer_load_dwordx4 v2, s[12:15], s41 offen offset:1024 sc1  lds
    buffer_load_dwordx4 v2, s[12:15], s41 offen offset:2048 sc1  lds
    buffer_load_dwordx4 v2, s[12:15], s41 offen offset:3072 sc1  lds
    s_add_u32 s41, s41, 4096
    s_waitcnt vmcnt(8)
    s_barrier
    s_add_u32 m0, s42, 131072
    s_nop 0
    buffer_load_dwordx4 v2, s[12:15], s41 offen offset:0 sc1  lds
    buffer_load_dwordx4 v2, s[12:15], s41 offen offset:1024 sc1  lds
    buffer_load_dwordx4 v2, s[12:15], s41 offen offset:2048 sc1  lds
    buffer_load_dwordx4 v2, s[12:15], s41 offen offset:3072 sc1  lds
    s_add_u32 s41, s41, 4096
    s_waitcnt vmcnt(8)
    s_barrier
    s_add_u32 m0, s42, 81920
    s_nop 0
    buffer_load_dwordx4 v2, s[12:15], s41 offen offset:0 sc1  lds
    buffer_load_dwordx4 v2, s[12:15], s41 offen offset:1024 sc1  lds
    buffer_load_dwordx4 v2, s[12:15], s41 offen offset:2048 sc1  lds
    buffer_load_dwordx4 v2, s[12:15], s41 offen offset:3072 sc1  lds
    s_add_u32 s41, s41, 4096
    s_add_u32 m0, s35, 0
    s_add_u32 s32, s40, 0
    buffer_load_dwordx4 v9, s[36:39], s32 offen  lds
    s_add_u32 m0, s35, 1024
    s_add_u32 s32, s40, 28672
    buffer_load_dwordx4 v9, s[36:39], s32 offen  lds
    s_add_u32 m0, s35, 8192
    s_add_u32 s32, s40, 128
    buffer_load_dwordx4 v9, s[36:39], s32 offen  lds
    s_add_u32 m0, s35, 9216
    s_add_u32 s32, s40, 28800
    buffer_load_dwordx4 v9, s[36:39], s32 offen  lds
    s_add_u32 s40, s40, 229376
    s_waitcnt vmcnt(12)
    s_barrier
    s_add_u32 m0, s42, 98304
    s_nop 0
    buffer_load_dwordx4 v2, s[12:15], s41 offen offset:0 sc1  lds
    buffer_load_dwordx4 v2, s[12:15], s41 offen offset:1024 sc1  lds
    buffer_load_dwordx4 v2, s[12:15], s41 offen offset:2048 sc1  lds
    buffer_load_dwordx4 v2, s[12:15], s41 offen offset:3072 sc1  lds
    s_add_u32 s41, s41, 4096
    s_add_u32 m0, s35, 16384
    s_add_u32 s32, s40, 0
    buffer_load_dwordx4 v9, s[36:39], s32 offen  lds
    s_add_u32 m0, s35, 17408
    s_add_u32 s32, s40, 28672
    buffer_load_dwordx4 v9, s[36:39], s32 offen  lds
    s_add_u32 m0, s35, 24576
    s_add_u32 s32, s40, 128
    buffer_load_dwordx4 v9, s[36:39], s32 offen  lds
    s_add_u32 m0, s35, 25600
    s_add_u32 s32, s40, 28800
    buffer_load_dwordx4 v9, s[36:39], s32 offen  lds
    s_add_u32 s40, s40, 229376
    s_waitcnt vmcnt(16)
    s_barrier
    s_add_u32 m0, s42, 114688
    s_nop 0
    buffer_load_dwordx4 v2, s[12:15], s41 offen offset:0 sc1  lds
    buffer_load_dwordx4 v2, s[12:15], s41 offen offset:1024 sc1  lds
    buffer_load_dwordx4 v2, s[12:15], s41 offen offset:2048 sc1  lds
    buffer_load_dwordx4 v2, s[12:15], s41 offen offset:3072 sc1  lds
    s_add_u32 s41, s41, 4096
    s_add_u32 m0, s35, 32768
    s_add_u32 s32, s40, 0
    buffer_load_dwordx4 v9, s[36:39], s32 offen  lds
    s_add_u32 m0, s35, 33792
    s_add_u32 s32, s40, 28672
    buffer_load_dwordx4 v9, s[36:39], s32 offen  lds
    s_add_u32 m0, s35, 40960
    s_add_u32 s32, s40, 128
    buffer_load_dwordx4 v9, s[36:39], s32 offen  lds
    s_add_u32 m0, s35, 41984
    s_add_u32 s32, s40, 28800
    buffer_load_dwordx4 v9, s[36:39], s32 offen  lds
    s_add_u32 s40, s40, 229376
    s_waitcnt vmcnt(20)
    s_barrier
    s_add_u32 m0, s42, 131072
    s_nop 0
    buffer_load_dwordx4 v2, s[12:15], s41 offen offset:0 sc1  lds
    buffer_load_dwordx4 v2, s[12:15], s41 offen offset:1024 sc1  lds
    buffer_load_dwordx4 v2, s[12:15], s41 offen offset:2048 sc1  lds
    buffer_load_dwordx4 v2, s[12:15], s41 offen offset:3072 sc1  lds
    s_add_u32 s41, s41, 4096
    v_lshlrev_b32 v12, 3, v0
    buffer_load_dwordx2 v[24:25], v12, s[12:15], s43 offen offset:0 sc1
    buffer_load_dwordx2 v[26:27], v12, s[12:15], s43 offen offset:512 sc1
    buffer_load_dwordx2 v[28:29], v12, s[12:15], s43 offen offset:1024 sc1
    buffer_load_dwordx2 v[30:31], v12, s[12:15], s43 offen offset:1536 sc1
    buffer_load_dwordx2 v[32:33], v12, s[12:15], s43 offen offset:2048 sc1
    buffer_load_dwordx2 v[34:35], v12, s[12:15], s43 offen offset:2560 sc1
    buffer_load_dwordx2 v[36:37], v12, s[12:15], s43 offen offset:3072 sc1
    buffer_load_dwordx2 v[38:39], v12, s[12:15], s43 offen offset:3584 sc1
    s_waitcnt vmcnt(24)
    s_barrier
    buffer_load_dword v16, v5, s[48:51], s47 offen
    s_waitcnt vmcnt(17)
    s_barrier
    s_waitcnt vmcnt(1)
    v_add_f32 v24, v24, v26
    v_add_f32 v25, v25, v27
    v_add_f32 v24, v24, v28
    v_add_f32 v25, v25, v29
    v_add_f32 v24, v24, v30
    v_add_f32 v25, v25, v31
    v_add_f32 v24, v24, v32
    v_add_f32 v25, v25, v33
    v_add_f32 v24, v24, v34
    v_add_f32 v25, v25, v35
    v_add_f32 v24, v24, v36
    v_add_f32 v25, v25, v37
    v_add_f32 v24, v24, v38
    v_add_f32 v25, v25, v39
    v_mov_b32 v40, v24
    s_nop 1
    v_permlane32_swap_b32 v24, v40
    s_nop 1
    v_add_f32 v24, v24, v40
    v_mov_b32 v40, v25
    s_nop 1
    v_permlane32_swap_b32 v25, v40
    s_nop 1
    v_add_f32 v25, v25, v40
    v_mul_f32 v24, 0xbb000000, v24
    v_mul_f32 v25, 0x3b000000, v25
    v_fma_f32 v25, -v24, v24, v25
    v_max_f32 v25, 0, v25
    v_add_f32 v25, 0x3727c5ac, v25
    v_rsq_f32 v44, v25
    s_nop 0
    v_mul_f32 v25, v25, v44
    v_mul_f32 v55, 0x3fb8aa3b, v44
    v_cvt_pk_bf16_f32 v42, v24, v24
    v_and_b32 v40, 0xffff0000, v42
    v_sub_f32 v41, v24, v40
    v_cvt_pk_bf16_f32 v52, v40, v41
    v_cvt_pk_bf16_f32 v42, v25, v25
    v_and_b32 v43, 0xffff0000, v42
    v_sub_f32 v41, v25, v43
    v_cvt_pk_bf16_f32 v53, v40, v43
    v_cvt_pk_bf16_f32 v54, v41, 0
    ds_write_b128 v11, v[52:55] offset:4096
    s_waitcnt lgkmcnt(0)
    s_waitcnt vmcnt(9)
    s_barrier
    s_barrier
    s_setprio 0
    s_branch LldE_65
LldE0_66:
LldE_65:
    s_mov_b32 s40, 786432
    s_add_u32 m0, s35, 0
    s_add_u32 s32, s40, 0
    buffer_load_dwordx4 v4, s[48:51], s32 offen  lds
    s_add_u32 m0, s35, 1024
    s_add_u32 s32, s40, 8192
    buffer_load_dwordx4 v4, s[48:51], s32 offen  lds
    s_add_u32 s40, s40, 65536
    s_add_u32 m0, s35, 8192
    s_add_u32 s32, s40, 0
    buffer_load_dwordx4 v4, s[48:51], s32 offen  lds
    s_add_u32 m0, s35, 9216
    s_add_u32 s32, s40, 8192
    buffer_load_dwordx4 v4, s[48:51], s32 offen  lds
    s_add_u32 s40, s40, 65536
    s_add_u32 m0, s35, 16384
    s_add_u32 s32, s40, 0
    buffer_load_dwordx4 v4, s[48:51], s32 offen  lds
    s_add_u32 m0, s35, 17408
    s_add_u32 s32, s40, 8192
    buffer_load_dwordx4 v4, s[48:51], s32 offen  lds
    s_add_u32 s40, s40, 65536
    s_add_u32 m0, s35, 24576
    s_add_u32 s32, s40, 0
    buffer_load_dwordx4 v4, s[48:51], s32 offen  lds
    s_add_u32 m0, s35, 25600
    s_add_u32 s32, s40, 8192
    buffer_load_dwordx4 v4, s[48:51], s32 offen  lds
    s_add_u32 s40, s40, 65536
    s_add_u32 m0, s35, 32768
    s_add_u32 s32, s40, 0
    buffer_load_dwordx4 v4, s[48:51], s32 offen  lds
    s_add_u32 m0, s35, 33792
    s_add_u32 s32, s40, 8192
    buffer_load_dwordx4 v4, s[48:51], s32 offen  lds
    s_add_u32 s40, s40, 65536
    s_add_u32 m0, s35, 40960
    s_add_u32 s32, s40, 0
    buffer_load_dwordx4 v4, s[48:51], s32 offen  lds
    s_add_u32 m0, s35, 41984
    s_add_u32 s32, s40, 8192
    buffer_load_dwordx4 v4, s[48:51], s32 offen  lds
    s_add_u32 s40, s40, 65536
    s_cmp_lt_u32 s2, 224
    s_cbranch_scc1 Lb1_67
    s_barrier
    s_barrier
Lb1_67:
    v_and_b32 v12, 3, v0
    v_lshlrev_b32 v13, 8, v1
    v_bfe_u32 v6, v0, 2, 2
    v_lshl_add_u32 v13, v6, 6, v13
    v_bfe_u32 v6, v0, 4, 1
    v_lshl_add_u32 v13, v6, 5, v13
    v_lshl_add_u32 v13, v12, 3, v13
    s_add_u32 s29, s35, 98304
    v_add_u32 v13, s29, v13
    v_add_u32 v12, s29, v2
    ds_write_b128 v12, v[72:75]
    ds_write_b128 v12, v[76:79] offset:1024
    ds_read_b64_tr_b16 v[72:73], v13
    ds_read_b64_tr_b16 v[74:75], v13 offset:512
    ds_read_b64_tr_b16 v[76:77], v13 offset:1024
    ds_read_b64_tr_b16 v[78:79], v13 offset:1536
    s_waitcnt lgkmcnt(6)
    ds_write_b128 v12, v[80:83]
    ds_write_b128 v12, v[84:87] offset:1024
    ds_read_b64_tr_b16 v[80:81], v13
    ds_read_b64_tr_b16 v[82:83], v13 offset:512
    ds_read_b64_tr_b16 v[84:85], v13 offset:1024
    ds_read_b64_tr_b16 v[86:87], v13 offset:1536
    s_waitcnt lgkmcnt(6)
    ds_write_b128 v12, v[88:91]
    ds_write_b128 v12, v[92:95] offset:1024
    ds_read_b64_tr_b16 v[88:89], v13
    ds_read_b64_tr_b16 v[90:91], v13 offset:512
    ds_read_b64_tr_b16 v[92:93], v13 offset:1024
    ds_read_b64_tr_b16 v[94:95], v13 offset:1536
    s_waitcnt lgkmcnt(6)
    ds_write_b128 v12, v[96:99]
    ds_write_b128 v12, v[100:103] offset:1024
    ds_read_b64_tr_b16 v[96:97], v13
    ds_read_b64_tr_b16 v[98:99], v13 offset:512
    ds_read_b64_tr_b16 v[100:101], v13 offset:1024
    ds_read_b64_tr_b16 v[102:103], v13 offset:1536
    s_waitcnt lgkmcnt(6)
    ds_write_b128 v12, v[104:107]
    ds_write_b128 v12, v[108:111] offset:1024
    ds_read_b64_tr_b16 v[104:105], v13
    ds_read_b64_tr_b16 v[106:107], v13 offset:512
    ds_read_b64_tr_b16 v[108:109], v13 offset:1024
    ds_read_b64_tr_b16 v[110:111], v13 offset:1536
    s_waitcnt lgkmcnt(6)
    ds_write_b128 v12, v[112:115]
    ds_write_b128 v12, v[116:119] offset:1024
    ds_read_b64_tr_b16 v[112:113], v13
    ds_read_b64_tr_b16 v[114:115], v13 offset:512
    ds_read_b64_tr_b16 v[116:117], v13 offset:1024
    ds_read_b64_tr_b16 v[118:119], v13 offset:1536
    s_waitcnt lgkmcnt(6)
    ds_write_b128 v12, v[120:123]
    ds_write_b128 v12, v[124:127] offset:1024
    ds_read_b64_tr_b16 v[120:121], v13
    ds_read_b64_tr_b16 v[122:123], v13 offset:512
    ds_read_b64_tr_b16 v[124:125], v13 offset:1024
    ds_read_b64_tr_b16 v[126:127], v13 offset:1536
    s_waitcnt lgkmcnt(6)
    ds_write_b128 v12, v[128:131]
    ds_write_b128 v12, v[132:135] offset:1024
    ds_read_b64_tr_b16 v[128:129], v13
    ds_read_b64_tr_b16 v[130:131], v13 offset:512
    ds_read_b64_tr_b16 v[132:133], v13 offset:1024
    ds_read_b64_tr_b16 v[134:135], v13 offset:1536
    s_waitcnt lgkmcnt(6)
    ds_write_b128 v12, v[136:139]
    ds_write_b128 v12, v[140:143] offset:1024
    ds_read_b64_tr_b16 v[136:137], v13
    ds_read_b64_tr_b16 v[138:139], v13 offset:512
    ds_read_b64_tr_b16 v[140:141], v13 offset:1024
    ds_read_b64_tr_b16 v[142:143], v13 offset:1536
    s_waitcnt lgkmcnt(6)
    ds_write_b128 v12, v[144:147]
    ds_write_b128 v12, v[148:151] offset:1024
    ds_read_b64_tr_b16 v[144:145], v13
    ds_read_b64_tr_b16 v[146:147], v13 offset:512
    ds_read_b64_tr_b16 v[148:149], v13 offset:1024
    ds_read_b64_tr_b16 v[150:151], v13 offset:1536
    s_waitcnt lgkmcnt(6)
    ds_write_b128 v12, v[152:155]
    ds_write_b128 v12, v[156:159] offset:1024
    ds_read_b64_tr_b16 v[152:153], v13
    ds_read_b64_tr_b16 v[154:155], v13 offset:512
    ds_read_b64_tr_b16 v[156:157], v13 offset:1024
    ds_read_b64_tr_b16 v[158:159], v13 offset:1536
    s_waitcnt lgkmcnt(6)
    ds_write_b128 v12, v[160:163]
    ds_write_b128 v12, v[164:167] offset:1024
    ds_read_b64_tr_b16 v[160:161], v13
    ds_read_b64_tr_b16 v[162:163], v13 offset:512
    ds_read_b64_tr_b16 v[164:165], v13 offset:1024
    ds_read_b64_tr_b16 v[166:167], v13 offset:1536
    s_waitcnt lgkmcnt(6)
    s_waitcnt lgkmcnt(0)
    s_cmp_ge_u32 s2, 224
    s_cbranch_scc1 Lb2_68
    s_barrier
    s_barrier
Lb2_68:
    s_add_u32 m0, s35, 49152
    s_add_u32 s32, s40, 0
    buffer_load_dwordx4 v4, s[48:51], s32 offen  lds
    s_add_u32 m0, s35, 50176
    s_add_u32 s32, s40, 8192
    buffer_load_dwordx4 v4, s[48:51], s32 offen  lds
    s_add_u32 s40, s40, 65536
    s_waitcnt vmcnt(4)
    s_add_u32 m0, s35, 57344
    s_add_u32 s32, s40, 0
    buffer_load_dwordx4 v4, s[48:51], s32 offen  lds
    s_add_u32 m0, s35, 58368
    s_add_u32 s32, s40, 8192
    buffer_load_dwordx4 v4, s[48:51], s32 offen  lds
    s_add_u32 s40, s40, 65536
    s_waitcnt vmcnt(4)
    s_add_u32 m0, s35, 65536
    s_add_u32 s32, s40, 0
    buffer_load_dwordx4 v4, s[48:51], s32 offen  lds
    s_add_u32 m0, s35, 66560
    s_add_u32 s32, s40, 8192
    buffer_load_dwordx4 v4, s[48:51], s32 offen  lds
    s_add_u32 s40, s40, 65536
    s_waitcnt vmcnt(4)
    s_add_u32 m0, s35, 73728
    s_add_u32 s32, s40, 0
    buffer_load_dwordx4 v4, s[48:51], s32 offen  lds
    s_add_u32 m0, s35, 74752
    s_add_u32 s32, s40, 8192
    buffer_load_dwordx4 v4, s[48:51], s32 offen  lds
    s_add_u32 s40, s40, 65536
    s_waitcnt vmcnt(4)
    s_add_u32 m0, s35, 81920
    s_add_u32 s32, s40, 0
    buffer_load_dwordx4 v4, s[48:51], s32 offen  lds
    s_add_u32 m0, s35, 82944
    s_add_u32 s32, s40, 8192
    buffer_load_dwordx4 v4, s[48:51], s32 offen  lds
    s_add_u32 s40, s40, 65536
    s_waitcnt vmcnt(4)
    s_add_u32 m0, s35, 90112
    s_add_u32 s32, s40, 0
    buffer_load_dwordx4 v4, s[48:51], s32 offen  lds
    s_add_u32 m0, s35, 91136
    s_add_u32 s32, s40, 8192
    buffer_load_dwordx4 v4, s[48:51], s32 offen  lds
    s_add_u32 s40, s40, 65536
    s_waitcnt vmcnt(4)
    s_cmp_lt_u32 s2, 224
    s_cbranch_scc1 Lrt_69
    buffer_load_dword v16, v5, s[48:51], s47 offen
Lrt_69:
    s_waitcnt vmcnt(63)
    s_barrier
    s_waitcnt vmcnt(0)
    s_lshr_b32 s29, s3, 1
    s_lshl_b32 s30, s29, 11
    s_add_u32 s30, s30, 98304
    v_add_u32 v6, s30, v2
    s_lshl_b32 s29, s29, 14
    s_and_b32 s30, s3, 1
    s_lshl_b32 s30, s30, 13
    s_add_u32 s29, s29, s30
    s_add_u32 s29, s29, 32768
    v_add_u32 v7, s29, v2
    s_setprio 0
    s_barrier
    s_barrier
    ds_read_b128 v[56:59], v6 offset:8192
    ds_read_b128 v[60:63], v6 offset:12288
    ds_read_b128 v[64:67], v6 offset:9216
    ds_read_b128 v[68:71], v6 offset:13312
    s_waitcnt lgkmcnt(0)
    s_barrier
    v_mfma_f32_32x32x16_bf16 v[24:39], v[72:75], v[56:59], 0
    ds_read_b128 v[8:11], v6 offset:24576
    ds_read_b128 v[12:15], v6 offset:28672
    v_mfma_f32_32x32x16_bf16 v[40:55], v[72:75], v[60:63], 0
    ds_read_b128 v[16:19], v6 offset:25600
    ds_read_b128 v[20:23], v6 offset:29696
    v_mfma_f32_32x32x16_bf16 v[24:39], v[76:79], v[64:67], v[24:39]
    v_mfma_f32_32x32x16_bf16 v[40:55], v[76:79], v[68:71], v[40:55]
    s_waitcnt lgkmcnt(0)
    s_barrier
    v_mfma_f32_32x32x16_bf16 v[24:39], v[80:83], v[8:11], v[24:39]
    ds_read_b128 v[56:59], v6 offset:40960
    ds_read_b128 v[60:63], v6 offset:45056
    v_mfma_f32_32x32x16_bf16 v[40:55], v[80:83], v[12:15], v[40:55]
    ds_read_b128 v[64:67], v6 offset:41984
    ds_read_b128 v[68:71], v6 offset:46080
    v_mfma_f32_32x32x16_bf16 v[24:39], v[84:87], v[16:19], v[24:39]
    v_mfma_f32_32x32x16_bf16 v[40:55], v[84:87], v[20:23], v[40:55]
    s_waitcnt lgkmcnt(0)
    s_barrier
    v_mfma_f32_32x32x16_bf16 v[24:39], v[88:91], v[56:59], v[24:39]
    ds_read_b128 v[8:11], v6 offset:57344
    ds_read_b128 v[12:15], v6 offset:61440
    v_mfma_f32_32x32x16_bf16 v[40:55], v[88:91], v[60:63], v[40:55]
    ds_read_b128 v[16:19], v6 offset:58368
    ds_read_b128 v[20:23], v6 offset:62464
    v_mfma_f32_32x32x16_bf16 v[24:39], v[92:95], v[64:67], v[24:39]
    v_mfma_f32_32x32x16_bf16 v[40:55], v[92:95], v[68:71], v[40:55]
    s_waitcnt lgkmcnt(0)
    s_barrier
    v_mfma_f32_32x32x16_bf16 v[24:39], v[96:99], v[8:11], v[24:39]
    ds_read_b128 v[56:59], v6 offset:8192
    ds_read_b128 v[60:63], v6 offset:12288
    v_mfma_f32_32x32x16_bf16 v[40:55], v[96:99], v[12:15], v[40:55]
    ds_read_b128 v[64:67], v6 offset:9216
    ds_read_b128 v[68:71], v6 offset:13312
    v_mfma_f32_32x32x16_bf16 v[24:39], v[100:103], v[16:19], v[24:39]
    v_mfma_f32_32x32x16_bf16 v[40:55], v[100:103], v[20:23], v[40:55]
    s_waitcnt lgkmcnt(0)
    s_barrier
    v_mfma_f32_32x32x16_bf16 v[24:39], v[104:107], v[56:59], v[24:39]
    ds_read_b128 v[8:11], v6 offset:24576
    ds_read_b128 v[12:15], v6 offset:28672
    v_mfma_f32_32x32x16_bf16 v[40:55], v[104:107], v[60:63], v[40:55]
    ds_read_b128 v[16:19], v6 offset:25600
    ds_read_b128 v[20:23], v6 offset:29696
    v_mfma_f32_32x32x16_bf16 v[24:39], v[108:111], v[64:67], v[24:39]
    v_mfma_f32_32x32x16_bf16 v[40:55], v[108:111], v[68:71], v[40:55]
    s_waitcnt lgkmcnt(0)
    s_barrier
    v_mfma_f32_32x32x16_bf16 v[24:39], v[112:115], v[8:11], v[24:39]
    ds_read_b128 v[56:59], v6 offset:40960
    ds_read_b128 v[60:63], v6 offset:45056
    v_mfma_f32_32x32x16_bf16 v[40:55], v[112:115], v[12:15], v[40:55]
    ds_read_b128 v[64:67], v6 offset:41984
    ds_read_b128 v[68:71], v6 offset:46080
    v_mfma_f32_32x32x16_bf16 v[24:39], v[116:119], v[16:19], v[24:39]
    v_mfma_f32_32x32x16_bf16 v[40:55], v[116:119], v[20:23], v[40:55]
    s_waitcnt lgkmcnt(0)
    s_barrier
    v_mfma_f32_32x32x16_bf16 v[24:39], v[120:123], v[56:59], v[24:39]
    ds_read_b128 v[8:11], v6 offset:57344
    ds_read_b128 v[12:15], v6 offset:61440
    v_mfma_f32_32x32x16_bf16 v[40:55], v[120:123], v[60:63], v[40:55]
    ds_read_b128 v[16:19], v6 offset:58368
    ds_read_b128 v[20:23], v6 offset:62464
    v_mfma_f32_32x32x16_bf16 v[24:39], v[124:127], v[64:67], v[24:39]
    v_mfma_f32_32x32x16_bf16 v[40:55], v[124:127], v[68:71], v[40:55]
    s_waitcnt lgkmcnt(0)
    s_barrier
    v_mfma_f32_32x32x16_bf16 v[24:39], v[128:131], v[8:11], v[24:39]
    ds_read_b128 v[56:59], v6 offset:8192
    ds_read_b128 v[60:63], v6 offset:12288
    v_mfma_f32_32x32x16_bf16 v[40:55], v[128:131], v[12:15], v[40:55]
    ds_read_b128 v[64:67], v6 offset:9216
    ds_read_b128 v[68:71], v6 offset:13312
    v_mfma_f32_32x32x16_bf16 v[24:39], v[132:135], v[16:19], v[24:39]
    v_mfma_f32_32x32x16_bf16 v[40:55], v[132:135], v[20:23], v[40:55]
    s_waitcnt lgkmcnt(0)
    s_barrier
    v_mfma_f32_32x32x16_bf16 v[24:39], v[136:139], v[56:59], v[24:39]
    ds_read_b128 v[8:11], v6 offset:24576
    ds_read_b128 v[12:15], v6 offset:28672
    v_mfma_f32_32x32x16_bf16 v[40:55], v[136:139], v[60:63], v[40:55]
    ds_read_b128 v[16:19], v6 offset:25600
    ds_read_b128 v[20:23], v6 offset:29696
    v_mfma_f32_32x32x16_bf16 v[24:39], v[140:143], v[64:67], v[24:39]
    v_mfma_f32_32x32x16_bf16 v[40:55], v[140:143], v[68:71], v[40:55]
    s_waitcnt lgkmcnt(0)
    s_barrier
    v_mfma_f32_32x32x16_bf16 v[24:39], v[144:147], v[8:11], v[24:39]
    ds_read_b128 v[56:59], v6 offset:40960
    ds_read_b128 v[60:63], v6 offset:45056
    v_mfma_f32_32x32x16_bf16 v[40:55], v[144:147], v[12:15], v[40:55]
    ds_read_b128 v[64:67], v6 offset:41984
    ds_read_b128 v[68:71], v6 offset:46080
    v_mfma_f32_32x32x16_bf16 v[24:39], v[148:151], v[16:19], v[24:39]
    v_mfma_f32_32x32x16_bf16 v[40:55], v[148:151], v[20:23], v[40:55]
    s_waitcnt lgkmcnt(0)
    s_barrier
    v_mfma_f32_32x32x16_bf16 v[24:39], v[152:155], v[56:59], v[24:39]
    ds_read_b128 v[8:11], v6 offset:57344
    ds_read_b128 v[12:15], v6 offset:61440
    v_mfma_f32_32x32x16_bf16 v[40:55], v[152:155], v[60:63], v[40:55]
    ds_read_b128 v[16:19], v6 offset:58368
    ds_read_b128 v[20:23], v6 offset:62464
    v_mfma_f32_32x32x16_bf16 v[24:39], v[156:159], v[64:67], v[24:39]
    v_mfma_f32_32x32x16_bf16 v[40:55], v[156:159], v[68:71], v[40:55]
    s_waitcnt lgkmcnt(0)
    v_mfma_f32_32x32x16_bf16 v[24:39], v[160:163], v[8:11], v[24:39]
    v_mfma_f32_32x32x16_bf16 v[40:55], v[160:163], v[12:15], v[40:55]
    v_mfma_f32_32x32x16_bf16 v[24:39], v[164:167], v[16:19], v[24:39]
    v_mfma_f32_32x32x16_bf16 v[40:55], v[164:167], v[20:23], v[40:55]
    s_barrier
    s_nop 10
    ds_write_b128 v7, v[24:27] offset:0
    ds_write_b128 v7, v[28:31] offset:1024
    ds_write_b128 v7, v[32:35] offset:2048
    s_barrier
    ds_write_b128 v7, v[36:39] offset:3072
    ds_write_b128 v7, v[40:43] offset:4096
    ds_write_b128 v7, v[44:47] offset:5120
    s_barrier
    ds_write_b128 v7, v[48:51] offset:6144
    ds_write_b128 v7, v[52:55] offset:7168
    s_waitcnt lgkmcnt(0)
    s_barrier
    s_endpgm
Lexit:
    s_endpgm
.section .rodata,"a"
.p2align 6
.amdhsa_kernel sequential_preLN__softmax_full_mha__dense_activation_mish__prompt_kernel
  .amdhsa_next_free_vgpr 168
  .amdhsa_next_free_sgpr 102
  .amdhsa_accum_offset 168
  .amdhsa_group_segment_fixed_size 0
  .amdhsa_kernarg_size 80
  .amdhsa_user_sgpr_count 2
  .amdhsa_user_sgpr_kernarg_segment_ptr 1
  .amdhsa_system_sgpr_workgroup_id_x 1
.end_amdhsa_kernel
```
